```python
import torch

def _softmax(x, axis=-1):
    return torch.softmax(x, dim=axis)
def _gelu(x):
    return torch.nn.functional.gelu(x, approximate="tanh")
def _silu(x):
    return torch.nn.functional.silu(x)
def _sigmoid(x):
    return torch.sigmoid(x)
def _layernorm(x, axis=-1, eps=1e-5):
    m = x.mean(dim=axis, keepdim=True)
    v = x.var(dim=axis, keepdim=True, unbiased=False)
    return (x - m) / torch.sqrt(v + eps)
def _scatter_add(tgt, idx, src, axis=0):
    return tgt.clone().index_add_(axis, idx, src)
def _segment_sum(src, seg, n):
    out = torch.zeros((n,) + src.shape[1:], dtype=src.dtype)
    return out.index_add_(0, seg, src)
def _pad(x, pw):
    flat = tuple(v for pair in reversed(pw) for v in pair)
    return torch.nn.functional.pad(x, flat)

kernel_name = 'recurrent_scan__compressed_kv_cla__swiglu_ffn__decode'

def setup_inputs():

    _w = (lambda a: (lambda t: t.to(torch.bfloat16) if t.is_floating_point() else t)(torch.as_tensor(a)))
    def _A_setup():
        B, H, Sq, Sk, D, M = 4, 32, 1, 4096, 128, 512
        Dc = 4 * D
        return {
            "x": _w((lambda *s: torch.randn(*s, dtype=torch.bfloat16) * 0.05)(B, Sq, M)),
            "c_kv": _w((lambda *s: torch.randn(*s, dtype=torch.bfloat16) * 0.8)(B, Sk, Dc)),
            "w_q": _w((lambda *s: torch.randn(*s, dtype=torch.bfloat16) * 1.6)(M, H, D) * (M ** -0.5)),
            "w_uk": _w((lambda *s: torch.randn(*s, dtype=torch.bfloat16) * 1.6)(Dc, H, D) * (Dc ** -0.5)),
            "w_uv": _w((lambda *s: torch.randn(*s, dtype=torch.bfloat16) * 0.8)(Dc, H, D) * (Dc ** -0.5)),
            "w_o": _w((lambda *s: torch.randn(*s, dtype=torch.bfloat16) * 0.8)(H, D, M) * ((H * D) ** -0.5)),
        }
    _A_in = _A_setup()

    def _B_setup():
        B, S, D, F = 4, 1, 512, 1792
        return {
            "x": _w((lambda *s: torch.randn(*s, dtype=torch.bfloat16) * 0.05)(B, S, D)),
            "w_gate": _w((lambda *s: torch.randn(*s, dtype=torch.bfloat16) * 0.2)(D, F)),
            "w_up": _w((lambda *s: torch.randn(*s, dtype=torch.bfloat16) * 0.2)(D, F)),
            "w_down": _w((lambda *s: torch.randn(*s, dtype=torch.bfloat16) * 0.2)(F, D)),
        }
    _B_in = _B_setup()

    return {
        "A_x": _A_in["x"],
        "A_c_kv": _A_in["c_kv"],
        "A_w_q": _A_in["w_q"],
        "A_w_uk": _A_in["w_uk"],
        "A_w_uv": _A_in["w_uv"],
        "A_w_o": _A_in["w_o"],
        "B_x": _B_in["x"],
        "B_w_gate": _B_in["w_gate"],
        "B_w_up": _B_in["w_up"],
        "B_w_down": _B_in["w_down"],
    }

def reference(A_x, A_c_kv, A_w_q, A_w_uk, A_w_uv, A_w_o, B_x, B_w_gate, B_w_up, B_w_down):
    def _A_ref(x, c_kv, w_q, w_uk, w_uv, w_o):
        B, Sq, M = x.shape[0], x.shape[1], x.shape[2]
        Sk = c_kv.shape[1]
        H, D = w_q.shape[1], w_q.shape[2]
        q = torch.einsum("bqm,mhd->bhqd", x, w_q)
        k = torch.einsum("bkc,chd->bhkd", c_kv, w_uk)
        v = torch.einsum("bkc,chd->bhkd", c_kv, w_uv)
        scores = torch.einsum("bhqd,bhkd->bhqk", q, k) * (D ** -0.5)
        off = Sk - Sq
        qi = torch.arange(Sq)[:, None]
        kj = torch.arange(Sk)[None, :]
        cmask = kj <= (qi + off)
        scores = torch.where(cmask[None, None], scores, -1e9)
        p = _softmax(scores, axis=-1)
        ctx = torch.einsum("bhqk,bhkd->bhqd", p, v)
        return torch.einsum("bhqd,hdm->bqm", ctx, w_o)

    def _B_ref(x, w_gate, w_up, w_down):
        g = _silu(x @ w_gate)
        u = x @ w_up
        return (g * u) @ w_down

    x = A_x
    xn = _layernorm(x, axis=-1)
    s = _A_ref(xn, A_c_kv, A_w_q, A_w_uk, A_w_uv, A_w_o)
    g = _silu(_B_ref(xn, B_w_gate, B_w_up, B_w_down))
    return x + s * g
```

```asm
; @launch kernel=ka_kernel grid=(256,1,1) block=(256,1,1) lds=163840
; @launch kernel=kb_kernel grid=(256,1,1) block=(256,1,1) lds=163840
.amdgcn_target "amdgcn-amd-amdhsa--gfx950"
.text
.globl ka_kernel
.p2align 8
.type ka_kernel,@function
ka_kernel:
    s_load_dwordx16 s[64:79], s[0:1], 0
    s_load_dwordx8 s[80:87], s[0:1], 64
    s_load_dwordx2 s[88:89], s[0:1], 96
    s_cmp_ge_u32 s2, 256
    s_cbranch_scc1 A_END
    v_and_b32 v1, 63, v0
    v_lshrrev_b32 v2, 6, v0
    s_and_b32 s3, s2, 7
    v_readfirstlane_b32 s5, v2
    s_lshr_b32 s6, s2, 3
    s_and_b32 s7, s6, 3
    s_lshl_b32 s7, s7, 3
    s_or_b32 s3, s3, s7
    s_lshr_b32 s4, s2, 5
    s_and_b32 s52, s4, 1
    s_lshr_b32 s53, s4, 1
    s_and_b32 s61, s2, 31
    s_cmp_gt_u32 s4, 1
    s_cselect_b32 s54, 1, 0
    s_cmp_gt_u32 s4, 5
    s_cselect_b32 s55, 1, 0
    s_sub_u32 s56, s4, s54
    s_sub_u32 s56, s56, s55
    s_lshl_b32 s56, s56, 5
    s_add_u32 s56, s56, s61
    s_lshr_b32 s55, s4, 2
    s_lshl_b32 s55, s55, 4
    s_bfe_u32 s54, s2, 0x20003
    s_lshl_b32 s54, s54, 2
    s_add_u32 s55, s55, s54
    s_and_b32 s54, s2, 3
    s_add_u32 s55, s55, s54
    s_add_u32 s55, s55, 192
    s_and_b32 s54, s4, 3
    s_cmp_eq_u32 s54, 1
    s_cselect_b32 s6, s55, s56
    s_cselect_b32 s61, 0, 4
    s_and_b32 s54, s2, 4
    s_or_b32 s61, s61, s54
    s_and_b32 s54, s6, 3
    s_lshr_b32 s7, s6, 2
    s_cmp_ge_u32 s7, 28
    s_cselect_b32 s56, 1, 0
    s_mul_i32 s55, s56, 28
    s_sub_u32 s55, s7, s55
    s_lshr_b32 s59, s6, 3
    s_and_b32 s60, s6, 7
    s_lshr_b32 s6, s2, 3
    s_and_b32 s58, s6, 1
    s_lshr_b32 s6, s2, 4
    s_lshl_b32 s6, s6, 3
    s_and_b32 s57, s2, 7
    s_or_b32 s57, s57, s6
    v_lshrrev_b32 v3, 4, v1
    v_and_b32 v4, 15, v1
    v_bfe_u32 v5, v1, 2, 2
    v_and_b32 v6, 3, v1
    v_lshlrev_b32 v31, 4, v1
    s_waitcnt lgkmcnt(0)
    s_mov_b32 s8, s64
    s_mov_b32 s9, s65
    s_mov_b32 s10, 4096
    s_mov_b32 s11, 0x00020000
    s_mov_b32 s16, s68
    s_mov_b32 s17, s69
    s_mov_b32 s18, 4194304
    s_mov_b32 s19, 0x00020000
    s_cmp_eq_u32 s56, 1
    s_cselect_b32 s78, s80, s78
    s_cselect_b32 s79, s81, s79
    s_mov_b32 s32, s78
    s_mov_b32 s33, s79
    s_mov_b32 s34, 1835008
    s_mov_b32 s35, 0x00020000
    s_mov_b32 s20, s70
    s_mov_b32 s21, s71
    s_mov_b32 s22, 4194304
    s_mov_b32 s23, 0x00020000
    s_mov_b32 s36, s88
    s_mov_b32 s37, s89
    s_mov_b32 s38, 268435456
    s_mov_b32 s39, 0x00020000
    s_mov_b32 s40, s82
    s_mov_b32 s41, s83
    s_mov_b32 s42, 1835008
    s_mov_b32 s43, 0x00020000
    s_mov_b32 s12, s66
    s_mov_b32 s13, s67
    s_mov_b32 s14, 16777216
    s_mov_b32 s15, 0x00020000
    s_mov_b32 s24, s72
    s_mov_b32 s25, s73
    s_mov_b32 s26, 4194304
    s_mov_b32 s27, 0x00020000
    s_mov_b32 s28, s74
    s_mov_b32 s29, s75
    s_mov_b32 s30, 4194304
    s_mov_b32 s31, 0x00020000
    s_mov_b32 s44, s84
    s_mov_b32 s45, s85
    s_mov_b32 s46, 4096
    s_mov_b32 s47, 0x00020000
    s_mov_b32 s48, s86
    s_mov_b32 s49, s87
    s_mov_b32 s50, 256
    s_mov_b32 s51, 0x00020000
    s_mov_b32 s40, s88
    s_mov_b32 s41, s89
    s_cmp_eq_u32 s61, 0
    s_cselect_b32 s34, 0, 1835008
    s_cselect_b32 s42, 0, 268435456
    s_mov_b32 s59, s3
    s_mov_b32 s60, s4
    s_and_b32 s6, s2, 7
    s_lshr_b32 s7, s2, 5
    s_bfe_u32 s53, s2, 0x20003
    s_add_u32 s3, s6, s7
    s_and_b32 s3, s3, 3
    s_lshl_b32 s3, s3, 3
    s_add_u32 s3, s3, s7
    s_lshr_b32 s6, s6, 2
    s_xor_b32 s6, s6, s7
    s_and_b32 s52, s6, 1
    s_lshl_b32 s6, s5, 10
    buffer_load_dwordx4 v[8:11], v31, s[8:11], s6 offen
    v_lshrrev_b32 v7, 3, v1
    v_and_b32 v2, 7, v1
    v_lshlrev_b32 v28, 1, v3
    v_xor_b32 v2, v2, v28
    v_lshlrev_b32 v2, 4, v2
    v_lshl_add_u32 v29, v7, 13, v2
    s_movk_i32 s6, 3584
    v_mul_lo_u32 v28, v7, s6
    v_add_u32 v28, v28, v2
    v_lshl_add_u32 v30, v7, 10, v2
    s_lshl_b32 s6, s5, 20
    s_lshl_b32 s7, s3, 8
    s_add_u32 s6, s6, s7
    s_lshl_b32 s7, s52, 7
    s_add_u32 s6, s6, s7
    s_lshl_b32 s7, s5, 15
    s_add_u32 m0, s7, 12288
    s_nop 0
    buffer_load_dwordx4 v29, s[16:19], s6 offen lds
    s_add_u32 s6, s6, 65536
    s_add_u32 m0, m0, 1024
    s_nop 0
    buffer_load_dwordx4 v29, s[16:19], s6 offen lds
    s_add_u32 s6, s6, 65536
    s_add_u32 m0, m0, 1024
    s_nop 0
    buffer_load_dwordx4 v29, s[16:19], s6 offen lds
    s_add_u32 s6, s6, 65536
    s_add_u32 m0, m0, 1024
    s_nop 0
    buffer_load_dwordx4 v29, s[16:19], s6 offen lds
    s_add_u32 s6, s6, 65536
    s_add_u32 m0, m0, 1024
    s_nop 0
    buffer_load_dwordx4 v29, s[16:19], s6 offen lds
    s_add_u32 s6, s6, 65536
    s_add_u32 m0, m0, 1024
    s_nop 0
    buffer_load_dwordx4 v29, s[16:19], s6 offen lds
    s_add_u32 s6, s6, 65536
    s_add_u32 m0, m0, 1024
    s_nop 0
    buffer_load_dwordx4 v29, s[16:19], s6 offen lds
    s_add_u32 s6, s6, 65536
    s_add_u32 m0, m0, 1024
    s_nop 0
    buffer_load_dwordx4 v29, s[16:19], s6 offen lds
    s_add_u32 s6, s6, 65536
    s_add_u32 m0, m0, 1024
    s_mov_b32 s61, s6
    v_lshl_add_u32 v2, v3, 2, v5
    v_and_b32 v7, 1, v6
    v_lshrrev_b32 v44, 1, v6
    v_lshlrev_b32 v7, 3, v7
    v_lshl_add_u32 v56, v44, 4, v7
    v_and_b32 v7, 1, v3
    v_lshlrev_b32 v7, 1, v7
    v_lshrrev_b32 v44, 1, v5
    v_add_u32 v7, v7, v44
    v_lshlrev_b32 v7, 1, v7
    s_lshl_b32 s6, s5, 1
    v_xor_b32 v7, s6, v7
    v_lshl_add_u32 v7, v7, 4, v56
    v_lshl_add_u32 v44, v2, 7, v7
    v_add_u32 v47, 0x10000, v44
    v_add_u32 v57, 155648, v44
    v_lshlrev_b32 v45, 10, v6
    v_lshl_add_u32 v45, v3, 4, v45
    v_add_u32 v45, 151552, v45
    v_lshrrev_b32 v46, 2, v1
    v_lshlrev_b32 v46, 6, v46
    v_and_b32 v7, 1, v6
    v_lshl_add_u32 v46, v7, 5, v46
    v_lshrrev_b32 v7, 1, v6
    v_lshl_add_u32 v46, v7, 3, v46
    s_lshl_b32 s6, s5, 10
    s_add_u32 s6, s6, 151552
    v_add_u32 v46, s6, v46
    s_waitcnt vmcnt(8)
    v_lshlrev_b32 v48, 16, v8
    v_and_b32 v49, 0xffff0000, v8
    v_lshlrev_b32 v50, 16, v9
    v_and_b32 v51, 0xffff0000, v9
    v_lshlrev_b32 v52, 16, v10
    v_and_b32 v53, 0xffff0000, v10
    v_lshlrev_b32 v54, 16, v11
    v_and_b32 v55, 0xffff0000, v11
    v_add_f32 v58, v48, v49
    v_add_f32 v59, v50, v51
    v_add_f32 v60, v52, v53
    v_add_f32 v61, v54, v55
    v_add_f32 v58, v58, v59
    v_add_f32 v60, v60, v61
    v_add_f32 v58, v58, v60
    s_nop 1
    v_add_f32_dpp v58, v58, v58 row_ror:8 row_mask:0xf bank_mask:0xf
    s_nop 1
    v_add_f32_dpp v58, v58, v58 row_ror:4 row_mask:0xf bank_mask:0xf
    s_nop 1
    v_add_f32_dpp v58, v58, v58 row_ror:2 row_mask:0xf bank_mask:0xf
    s_nop 1
    v_add_f32_dpp v58, v58, v58 row_ror:1 row_mask:0xf bank_mask:0xf
    v_mov_b32 v59, v58
    s_nop 1
    v_permlane16_swap_b32 v58, v59
    s_nop 1
    v_add_f32 v58, v58, v59
    v_mov_b32 v59, v58
    s_nop 1
    v_permlane32_swap_b32 v58, v59
    s_nop 1
    v_add_f32 v58, v58, v59
    v_mul_f32 v58, 0x3b000000, v58
    v_sub_f32 v48, v48, v58
    v_sub_f32 v49, v49, v58
    v_sub_f32 v50, v50, v58
    v_sub_f32 v51, v51, v58
    v_sub_f32 v52, v52, v58
    v_sub_f32 v53, v53, v58
    v_sub_f32 v54, v54, v58
    v_sub_f32 v55, v55, v58
    v_mul_f32 v59, v48, v48
    v_fmac_f32 v59, v49, v49
    v_fmac_f32 v59, v50, v50
    v_fmac_f32 v59, v51, v51
    v_fmac_f32 v59, v52, v52
    v_fmac_f32 v59, v53, v53
    v_fmac_f32 v59, v54, v54
    v_fmac_f32 v59, v55, v55
    s_nop 1
    v_add_f32_dpp v59, v59, v59 row_ror:8 row_mask:0xf bank_mask:0xf
    s_nop 1
    v_add_f32_dpp v59, v59, v59 row_ror:4 row_mask:0xf bank_mask:0xf
    s_nop 1
    v_add_f32_dpp v59, v59, v59 row_ror:2 row_mask:0xf bank_mask:0xf
    s_nop 1
    v_add_f32_dpp v59, v59, v59 row_ror:1 row_mask:0xf bank_mask:0xf
    v_mov_b32 v60, v59
    s_nop 1
    v_permlane16_swap_b32 v59, v60
    s_nop 1
    v_add_f32 v59, v59, v60
    v_mov_b32 v60, v59
    s_nop 1
    v_permlane32_swap_b32 v59, v60
    s_nop 1
    v_add_f32 v59, v59, v60
    v_mov_b32 v60, 0x3727c5ac
    v_fmac_f32 v60, 0x3b000000, v59
    v_rsq_f32 v60, v60
    s_nop 0
    v_mul_f32 v48, v48, v60
    v_mul_f32 v49, v49, v60
    v_mul_f32 v50, v50, v60
    v_mul_f32 v51, v51, v60
    v_mul_f32 v52, v52, v60
    v_mul_f32 v53, v53, v60
    v_mul_f32 v54, v54, v60
    v_mul_f32 v55, v55, v60
    v_cvt_pk_bf16_f32 v60, v48, v49
    v_cvt_pk_bf16_f32 v61, v50, v51
    v_cvt_pk_bf16_f32 v62, v52, v53
    v_cvt_pk_bf16_f32 v63, v54, v55
    ds_write_b64 v46, v[60:61]
    ds_write_b64 v46, v[62:63] offset:16
    s_waitcnt lgkmcnt(0)
    s_barrier
    s_lshl_b32 s6, s54, 8
    v_add_u32 v58, s6, v45
    ds_read_b128 v[200:203], v58 offset:0
    ds_read_b128 v[204:207], v58 offset:64
    ds_read_b128 v[208:211], v58 offset:128
    ds_read_b128 v[212:215], v58 offset:192
    ds_read_b128 v[64:67], v45 offset:0
    ds_read_b128 v[68:71], v45 offset:64
    ds_read_b128 v[72:75], v45 offset:128
    ds_read_b128 v[76:79], v45 offset:192
    ds_read_b128 v[80:83], v45 offset:256
    ds_read_b128 v[84:87], v45 offset:320
    ds_read_b128 v[88:91], v45 offset:384
    ds_read_b128 v[92:95], v45 offset:448
    ds_read_b128 v[96:99], v45 offset:512
    ds_read_b128 v[100:103], v45 offset:576
    ds_read_b128 v[104:107], v45 offset:640
    ds_read_b128 v[108:111], v45 offset:704
    ds_read_b128 v[112:115], v45 offset:768
    ds_read_b128 v[116:119], v45 offset:832
    ds_read_b128 v[120:123], v45 offset:896
    ds_read_b128 v[124:127], v45 offset:960
    s_mov_b32 s6, s61
    s_nop 0
    buffer_load_dwordx4 v29, s[16:19], s6 offen lds
    s_add_u32 s6, s6, 65536
    s_add_u32 m0, m0, 1024
    s_nop 0
    buffer_load_dwordx4 v29, s[16:19], s6 offen lds
    s_add_u32 s6, s6, 65536
    s_add_u32 m0, m0, 1024
    s_nop 0
    buffer_load_dwordx4 v29, s[16:19], s6 offen lds
    s_add_u32 s6, s6, 65536
    s_add_u32 m0, m0, 1024
    s_nop 0
    buffer_load_dwordx4 v29, s[16:19], s6 offen lds
    s_add_u32 s6, s6, 65536
    s_add_u32 m0, m0, 1024
    s_nop 0
    buffer_load_dwordx4 v29, s[16:19], s6 offen lds
    s_add_u32 s6, s6, 65536
    s_add_u32 m0, m0, 1024
    s_nop 0
    buffer_load_dwordx4 v29, s[16:19], s6 offen lds
    s_add_u32 s6, s6, 65536
    s_add_u32 m0, m0, 1024
    s_nop 0
    buffer_load_dwordx4 v29, s[16:19], s6 offen lds
    s_add_u32 s6, s6, 65536
    s_add_u32 m0, m0, 1024
    s_nop 0
    buffer_load_dwordx4 v29, s[16:19], s6 offen lds
    s_lshl_b32 s6, s54, 7
    s_lshl_b32 s7, s5, 5
    s_add_u32 s6, s6, s7
    s_mul_i32 s6, s6, 3584
    s_lshl_b32 s7, s55, 7
    s_add_u32 s6, s6, s7
    s_lshl_b32 s7, s5, 15
    s_add_u32 m0, s7, 28672
    s_nop 0
    buffer_load_dwordx4 v28, s[32:35], s6 offen lds
    s_add_u32 s6, s6, 28672
    s_add_u32 m0, m0, 1024
    s_nop 0
    buffer_load_dwordx4 v28, s[32:35], s6 offen lds
    s_add_u32 s6, s6, 28672
    s_add_u32 m0, m0, 1024
    s_nop 0
    buffer_load_dwordx4 v28, s[32:35], s6 offen lds
    s_add_u32 s6, s6, 28672
    s_add_u32 m0, m0, 1024
    s_nop 0
    buffer_load_dwordx4 v28, s[32:35], s6 offen lds
    v_lshrrev_b32 v7, 2, v4
    v_and_b32 v2, 3, v4
    v_lshl_add_u32 v7, v7, 3, v2
    v_lshlrev_b32 v7, 13, v7
    v_lshl_add_u32 v7, v3, 4, v7
    s_lshl_b32 s6, s53, 7
    s_lshl_b32 s7, s5, 5
    s_add_u32 s6, s6, s7
    s_lshl_b32 s6, s6, 13
    s_lshl_b32 s7, s3, 8
    s_add_u32 s6, s6, s7
    s_lshl_b32 s7, s52, 7
    s_add_u32 s6, s6, s7
    s_add_u32 s7, s6, 32768
    buffer_load_dwordx4 v[12:15], v7, s[20:23], s6 offen offset:0
    buffer_load_dwordx4 v[16:19], v7, s[20:23], s6 offen offset:64
    buffer_load_dwordx4 v[20:23], v7, s[20:23], s7 offen offset:0
    buffer_load_dwordx4 v[24:27], v7, s[20:23], s7 offen offset:64
    v_mov_b32 v40, -1
    v_mov_b32 v41, -1
    v_mov_b32 v42, -1
    v_mov_b32 v43, -1
    v_lshlrev_b32 v7, 4, v0
    s_lshl_b32 s6, s59, 2
    s_and_b32 s7, s60, 3
    s_add_u32 s6, s6, s7
    s_lshl_b32 s6, s6, 15
    s_lshr_b32 s7, s60, 2
    s_lshl_b32 s7, s7, 14
    s_add_u32 s6, s6, s7
    s_add_u32 s6, s6, 4194304
    buffer_store_dwordx4 v[40:43], v7, s[36:39], s6 offen sc1
    s_add_u32 s6, s6, 4096
    buffer_store_dwordx4 v[40:43], v7, s[36:39], s6 offen sc1
    s_add_u32 s6, s6, 4096
    buffer_store_dwordx4 v[40:43], v7, s[36:39], s6 offen sc1
    s_add_u32 s6, s6, 4096
    buffer_store_dwordx4 v[40:43], v7, s[36:39], s6 offen sc1
    s_mul_i32 s6, s2, 4992
    s_mul_i32 s7, s5, 1248
    s_add_u32 s6, s6, s7
    s_add_u32 s6, s6, 1048576
    buffer_store_dwordx4 v[40:43], v31, s[36:39], s6 offen sc1
    v_cmp_gt_u32 vcc, 14, v1
    s_and_saveexec_b64 s[62:63], vcc
    buffer_store_dwordx4 v[40:43], v31, s[36:39], s6 offen offset:1024 sc1
    s_lshl_b32 s6, s59, 10
    s_lshl_b32 s7, s60, 7
    s_add_u32 s6, s6, s7
    s_lshl_b32 s7, s5, 5
    s_add_u32 s6, s6, s7
    s_add_u32 s6, s6, 589824
    v_cmp_gt_u32 vcc, 2, v1
    s_and_b64 exec, exec, vcc
    buffer_store_dwordx4 v[40:43], v31, s[36:39], s6 offen sc1
    s_mov_b64 exec, s[62:63]
    s_waitcnt vmcnt(11) lgkmcnt(0)
    s_barrier
    ds_read_b64_tr_b16 v[216:217], v44 offset:28672
    ds_read_b64_tr_b16 v[218:219], v44 offset:30720
    ds_read_b64_tr_b16 v[220:221], v44 offset:61440
    ds_read_b64_tr_b16 v[222:223], v44 offset:63488
    ds_read_b64_tr_b16 v[224:225], v47 offset:28672
    ds_read_b64_tr_b16 v[226:227], v47 offset:30720
    ds_read_b64_tr_b16 v[228:229], v47 offset:61440
    ds_read_b64_tr_b16 v[230:231], v47 offset:63488
    ds_read_b64_tr_b16 v[128:129], v44 offset:12288
    ds_read_b64_tr_b16 v[130:131], v44 offset:14336
    s_waitcnt lgkmcnt(8)
    v_mfma_f32_16x16x32_bf16 v[232:235], v[216:219], v[200:203], 0
    s_waitcnt lgkmcnt(6)
    v_mfma_f32_16x16x32_bf16 v[232:235], v[220:223], v[204:207], v[232:235]
    s_waitcnt lgkmcnt(4)
    v_mfma_f32_16x16x32_bf16 v[232:235], v[224:227], v[208:211], v[232:235]
    s_waitcnt lgkmcnt(2)
    v_mfma_f32_16x16x32_bf16 v[232:235], v[228:231], v[212:215], v[232:235]
    ds_read_b64_tr_b16 v[132:133], v44 offset:16384
    ds_read_b64_tr_b16 v[134:135], v44 offset:18432
    ds_read_b64_tr_b16 v[136:137], v44 offset:20480
    ds_read_b64_tr_b16 v[138:139], v44 offset:22528
    ds_read_b64_tr_b16 v[140:141], v44 offset:24576
    ds_read_b64_tr_b16 v[142:143], v44 offset:26624
    ds_read_b64_tr_b16 v[144:145], v44 offset:45056
    ds_read_b64_tr_b16 v[146:147], v44 offset:47104
    ds_read_b64_tr_b16 v[148:149], v44 offset:49152
    ds_read_b64_tr_b16 v[150:151], v44 offset:51200
    ds_read_b64_tr_b16 v[152:153], v44 offset:53248
    ds_read_b64_tr_b16 v[154:155], v44 offset:55296
    s_waitcnt lgkmcnt(12)
    v_mfma_f32_16x16x32_bf16 v[192:195], v[128:131], v[64:67], 0
    ds_read_b64_tr_b16 v[156:157], v44 offset:57344
    ds_read_b64_tr_b16 v[158:159], v44 offset:59392
    s_waitcnt lgkmcnt(12)
    v_mfma_f32_16x16x32_bf16 v[196:199], v[132:135], v[68:71], 0
    ds_read_b64_tr_b16 v[160:161], v47 offset:12288
    ds_read_b64_tr_b16 v[162:163], v47 offset:14336
    s_waitcnt lgkmcnt(12)
    v_mfma_f32_16x16x32_bf16 v[192:195], v[136:139], v[72:75], v[192:195]
    ds_read_b64_tr_b16 v[164:165], v47 offset:16384
    ds_read_b64_tr_b16 v[166:167], v47 offset:18432
    s_waitcnt lgkmcnt(12)
    v_mfma_f32_16x16x32_bf16 v[196:199], v[140:143], v[76:79], v[196:199]
    ds_read_b64_tr_b16 v[168:169], v47 offset:20480
    ds_read_b64_tr_b16 v[170:171], v47 offset:22528
    s_waitcnt lgkmcnt(12)
    v_mfma_f32_16x16x32_bf16 v[192:195], v[144:147], v[80:83], v[192:195]
    ds_read_b64_tr_b16 v[172:173], v47 offset:24576
    ds_read_b64_tr_b16 v[174:175], v47 offset:26624
    s_waitcnt lgkmcnt(12)
    v_mfma_f32_16x16x32_bf16 v[196:199], v[148:151], v[84:87], v[196:199]
    ds_read_b64_tr_b16 v[176:177], v47 offset:45056
    ds_read_b64_tr_b16 v[178:179], v47 offset:47104
    s_waitcnt lgkmcnt(12)
    v_mfma_f32_16x16x32_bf16 v[192:195], v[152:155], v[88:91], v[192:195]
    ds_read_b64_tr_b16 v[180:181], v47 offset:49152
    ds_read_b64_tr_b16 v[182:183], v47 offset:51200
    s_waitcnt lgkmcnt(12)
    v_mfma_f32_16x16x32_bf16 v[196:199], v[156:159], v[92:95], v[196:199]
    ds_read_b64_tr_b16 v[184:185], v47 offset:53248
    ds_read_b64_tr_b16 v[186:187], v47 offset:55296
    s_waitcnt lgkmcnt(12)
    v_mfma_f32_16x16x32_bf16 v[192:195], v[160:163], v[96:99], v[192:195]
    ds_read_b64_tr_b16 v[188:189], v47 offset:57344
    ds_read_b64_tr_b16 v[190:191], v47 offset:59392
    s_waitcnt lgkmcnt(12)
    v_mfma_f32_16x16x32_bf16 v[196:199], v[164:167], v[100:103], v[196:199]
    s_waitcnt lgkmcnt(10)
    v_mfma_f32_16x16x32_bf16 v[192:195], v[168:171], v[104:107], v[192:195]
    s_waitcnt lgkmcnt(8)
    v_mfma_f32_16x16x32_bf16 v[196:199], v[172:175], v[108:111], v[196:199]
    s_waitcnt lgkmcnt(6)
    v_mfma_f32_16x16x32_bf16 v[192:195], v[176:179], v[112:115], v[192:195]
    s_waitcnt lgkmcnt(4)
    v_mfma_f32_16x16x32_bf16 v[196:199], v[180:183], v[116:119], v[196:199]
    s_waitcnt lgkmcnt(2)
    v_mfma_f32_16x16x32_bf16 v[192:195], v[184:187], v[120:123], v[192:195]
    s_waitcnt lgkmcnt(0)
    v_mfma_f32_16x16x32_bf16 v[196:199], v[188:191], v[124:127], v[196:199]
    s_lshl_b32 s6, s54, 1
    s_add_u32 s6, s6, s56
    s_mul_i32 s6, s6, 28672
    s_lshl_b32 s7, s55, 8
    s_add_u32 s6, s6, s7
    s_lshl_b32 s7, s5, 6
    s_add_u32 s6, s6, s7
    s_add_u32 s6, s6, 262144
    s_movk_i32 s7, 7168
    v_mul_lo_u32 v58, v4, s7
    v_lshl_add_u32 v58, v3, 4, v58
    v_lshlrev_b32 v59, 7, v4
    v_lshl_add_u32 v59, v3, 3, v59
    s_lshl_b32 s7, s5, 5
    s_add_u32 s7, s7, 147456
    v_add_u32 v59, s7, v59
    v_cmp_gt_u32 vcc, 4, v4
    s_and_saveexec_b64 s[62:63], vcc
    buffer_store_dwordx4 v[232:235], v58, s[40:43], s6 offen sc1
    s_nop 4
    v_add_f32 v192, v192, v196
    v_add_f32 v193, v193, v197
    v_add_f32 v194, v194, v198
    v_add_f32 v195, v195, v199
    v_cvt_pk_bf16_f32 v192, v192, v193
    v_cvt_pk_bf16_f32 v193, v194, v195
    ds_write_b64 v59, v[192:193]
    s_mov_b64 exec, s[62:63]
    v_lshlrev_b32 v59, 7, v6
    v_lshl_add_u32 v59, v3, 4, v59
    v_add_u32 v59, 147456, v59
    s_waitcnt lgkmcnt(0)
    s_barrier
    ds_read_b128 v[64:67], v59
    ds_read_b128 v[68:71], v59 offset:64
    s_lshl_b32 s6, s52, 17
    s_lshr_b32 s7, s3, 4
    s_lshl_b32 s7, s7, 14
    s_add_u32 s6, s6, s7
    s_lshl_b32 s7, s53, 2
    s_add_u32 s7, s7, s5
    s_lshl_b32 s7, s7, 10
    s_add_u32 s6, s6, s7
    s_and_b32 s7, s3, 15
    s_lshl_b32 s7, s7, 4
    s_add_u32 s6, s6, s7
    s_add_u32 s6, s6, 0
    v_lshlrev_b32 v58, 15, v4
    v_lshl_add_u32 v58, v3, 8, v58
    s_mov_b32 s7, 0x3e0293ee
    s_waitcnt vmcnt(8) lgkmcnt(0)
    v_mfma_f32_16x16x32_bf16 v[72:75], v[12:15], v[64:67], 0
    v_mfma_f32_16x16x32_bf16 v[76:79], v[20:23], v[64:67], 0
    v_mfma_f32_16x16x32_bf16 v[72:75], v[16:19], v[68:71], v[72:75]
    v_mfma_f32_16x16x32_bf16 v[76:79], v[24:27], v[68:71], v[76:79]
    v_cmp_gt_u32 vcc, 4, v4
    s_and_saveexec_b64 s[62:63], vcc
    s_nop 7
    v_mul_f32 v72, s7, v72
    v_mul_f32 v73, s7, v73
    v_mul_f32 v74, s7, v74
    v_mul_f32 v75, s7, v75
    v_mul_f32 v76, s7, v76
    v_mul_f32 v77, s7, v77
    v_mul_f32 v78, s7, v78
    v_mul_f32 v79, s7, v79
    v_cvt_pk_bf16_f32 v72, v72, v73
    v_cvt_pk_bf16_f32 v73, v74, v75
    v_cvt_pk_bf16_f32 v74, v76, v77
    v_cvt_pk_bf16_f32 v75, v78, v79
    buffer_store_dwordx4 v[72:75], v58, s[36:39], s6 offen sc1
    s_mov_b64 exec, s[62:63]
    s_waitcnt vmcnt(0)
A_END:
    s_endpgm
.globl kb_kernel
.p2align 8
.type kb_kernel,@function
kb_kernel:
    s_load_dwordx16 s[64:79], s[0:1], 0
    s_load_dwordx8 s[80:87], s[0:1], 64
    s_load_dwordx2 s[88:89], s[0:1], 96
    s_cmp_ge_u32 s2, 256
    s_cbranch_scc1 B_END
    v_and_b32 v1, 63, v0
    v_lshrrev_b32 v2, 6, v0
    s_and_b32 s3, s2, 7
    v_readfirstlane_b32 s5, v2
    s_lshr_b32 s6, s2, 3
    s_and_b32 s7, s6, 3
    s_lshl_b32 s7, s7, 3
    s_or_b32 s3, s3, s7
    s_lshr_b32 s4, s2, 5
    s_and_b32 s52, s4, 1
    s_lshr_b32 s53, s4, 1
    s_min_u32 s6, s2, 223
    s_and_b32 s54, s6, 3
    s_lshr_b32 s7, s6, 2
    s_cmp_ge_u32 s7, 28
    s_cselect_b32 s56, 1, 0
    s_mul_i32 s55, s56, 28
    s_sub_u32 s55, s7, s55
    s_lshr_b32 s59, s6, 3
    s_and_b32 s60, s6, 7
    s_lshr_b32 s6, s2, 3
    s_and_b32 s58, s6, 1
    s_lshr_b32 s6, s2, 4
    s_lshl_b32 s6, s6, 3
    s_and_b32 s57, s2, 7
    s_or_b32 s57, s57, s6
    v_lshrrev_b32 v3, 4, v1
    v_and_b32 v4, 15, v1
    v_bfe_u32 v5, v1, 2, 2
    v_and_b32 v6, 3, v1
    v_lshlrev_b32 v31, 4, v1
    s_waitcnt lgkmcnt(0)
    s_mov_b32 s8, s64
    s_mov_b32 s9, s65
    s_mov_b32 s10, 4096
    s_mov_b32 s11, 0x00020000
    s_mov_b32 s16, s68
    s_mov_b32 s17, s69
    s_mov_b32 s18, 4194304
    s_mov_b32 s19, 0x00020000
    s_cmp_eq_u32 s56, 1
    s_cselect_b32 s78, s80, s78
    s_cselect_b32 s79, s81, s79
    s_mov_b32 s32, s78
    s_mov_b32 s33, s79
    s_mov_b32 s34, 1835008
    s_mov_b32 s35, 0x00020000
    s_mov_b32 s20, s70
    s_mov_b32 s21, s71
    s_mov_b32 s22, 4194304
    s_mov_b32 s23, 0x00020000
    s_mov_b32 s36, s88
    s_mov_b32 s37, s89
    s_mov_b32 s38, 268435456
    s_mov_b32 s39, 0x00020000
    s_mov_b32 s40, s82
    s_mov_b32 s41, s83
    s_mov_b32 s42, 1835008
    s_mov_b32 s43, 0x00020000
    s_mov_b32 s12, s66
    s_mov_b32 s13, s67
    s_mov_b32 s14, 16777216
    s_mov_b32 s15, 0x00020000
    s_mov_b32 s24, s72
    s_mov_b32 s25, s73
    s_mov_b32 s26, 4194304
    s_mov_b32 s27, 0x00020000
    s_mov_b32 s28, s74
    s_mov_b32 s29, s75
    s_mov_b32 s30, 4194304
    s_mov_b32 s31, 0x00020000
    s_mov_b32 s44, s84
    s_mov_b32 s45, s85
    s_mov_b32 s46, 4096
    s_mov_b32 s47, 0x00020000
    s_mov_b32 s48, s86
    s_mov_b32 s49, s87
    s_mov_b32 s50, 256
    s_mov_b32 s51, 0x00020000
    s_bfe_u32 s6, s2, 0x20003
    s_lshl_b32 s7, s6, 1
    s_add_u32 s7, s7, s2
    s_and_b32 s7, s7, 7
    s_lshl_b32 s6, s6, 3
    s_add_u32 s3, s6, s7
    s_lshr_b32 s6, s57, 5
    s_lshl_b32 s6, s6, 1
    s_add_u32 s6, s6, s58
    s_lshl_b32 s6, s6, 14
    s_lshl_b32 s7, s5, 12
    s_add_u32 s6, s6, s7
    s_add_u32 s6, s6, 0
    s_add_u32 s7, s6, 131072
    buffer_load_dwordx4 v[128:131], v31, s[36:39], s6 offen offset:0
    buffer_load_dwordx4 v[132:135], v31, s[36:39], s6 offen offset:1024
    buffer_load_dwordx4 v[136:139], v31, s[36:39], s6 offen offset:2048
    buffer_load_dwordx4 v[140:143], v31, s[36:39], s6 offen offset:3072
    buffer_load_dwordx4 v[144:147], v31, s[36:39], s7 offen offset:0
    buffer_load_dwordx4 v[148:151], v31, s[36:39], s7 offen offset:1024
    buffer_load_dwordx4 v[152:155], v31, s[36:39], s7 offen offset:2048
    buffer_load_dwordx4 v[156:159], v31, s[36:39], s7 offen offset:3072
    s_mul_i32 s6, s5, 7168
    s_lshl_b32 s7, s59, 8
    s_add_u32 s6, s6, s7
    s_add_u32 s6, s6, 262144
    v_lshlrev_b32 v58, 2, v1
    buffer_load_dword v160, v58, s[36:39], s6 offen
    s_add_u32 s6, s6, 28672
    buffer_load_dword v161, v58, s[36:39], s6 offen
    s_add_u32 s6, s6, 28672
    buffer_load_dword v162, v58, s[36:39], s6 offen
    s_add_u32 s6, s6, 28672
    buffer_load_dword v163, v58, s[36:39], s6 offen
    s_add_u32 s6, s6, 28672
    buffer_load_dword v164, v58, s[36:39], s6 offen
    s_add_u32 s6, s6, 28672
    buffer_load_dword v165, v58, s[36:39], s6 offen
    s_add_u32 s6, s6, 28672
    buffer_load_dword v166, v58, s[36:39], s6 offen
    s_add_u32 s6, s6, 28672
    buffer_load_dword v167, v58, s[36:39], s6 offen
    v_lshrrev_b32 v7, 3, v1
    v_and_b32 v2, 7, v1
    v_lshlrev_b32 v28, 1, v3
    v_xor_b32 v2, v2, v28
    v_lshlrev_b32 v2, 4, v2
    v_lshl_add_u32 v30, v7, 10, v2
    s_lshl_b32 s6, s59, 6
    s_lshl_b32 s7, s5, 4
    s_add_u32 s6, s6, s7
    s_lshl_b32 s6, s6, 10
    s_lshl_b32 s7, s60, 7
    s_add_u32 s6, s6, s7
    s_lshl_b32 s7, s5, 11
    s_add_u32 m0, s7, 155648
    s_nop 0
    buffer_load_dwordx4 v30, s[40:43], s6 offen lds
    s_add_u32 s6, s6, 8192
    s_add_u32 m0, m0, 1024
    s_nop 0
    buffer_load_dwordx4 v30, s[40:43], s6 offen lds
    v_xor_b32 v200, 0, v31
    v_xor_b32 v201, 32, v31
    v_xor_b32 v202, 64, v31
    v_xor_b32 v203, 96, v31
    v_xor_b32 v204, 128, v31
    v_xor_b32 v205, 160, v31
    v_xor_b32 v206, 192, v31
    v_xor_b32 v207, 224, v31
    s_lshl_b32 s61, s57, 17
    s_lshl_b32 s7, s5, 15
    s_add_u32 s61, s61, s7
    s_mov_b32 m0, s7
    s_lshl_b32 s7, s5, 15
    s_add_u32 m0, s7, 0
    s_add_u32 s6, s61, 0
    buffer_load_dwordx4 v200, s[12:15], s6 offen offset:0 lds
    buffer_load_dwordx4 v201, s[12:15], s6 offen offset:1024 lds
    buffer_load_dwordx4 v202, s[12:15], s6 offen offset:2048 lds
    buffer_load_dwordx4 v203, s[12:15], s6 offen offset:3072 lds
    s_lshl_b32 s7, s5, 15
    s_add_u32 m0, s7, 4096
    s_add_u32 s6, s61, 4096
    buffer_load_dwordx4 v204, s[12:15], s6 offen offset:0 lds
    buffer_load_dwordx4 v205, s[12:15], s6 offen offset:1024 lds
    buffer_load_dwordx4 v206, s[12:15], s6 offen offset:2048 lds
    buffer_load_dwordx4 v207, s[12:15], s6 offen offset:3072 lds
    s_lshl_b32 s7, s5, 15
    s_add_u32 m0, s7, 8192
    s_add_u32 s6, s61, 8192
    buffer_load_dwordx4 v200, s[12:15], s6 offen offset:0 lds
    buffer_load_dwordx4 v201, s[12:15], s6 offen offset:1024 lds
    buffer_load_dwordx4 v202, s[12:15], s6 offen offset:2048 lds
    buffer_load_dwordx4 v203, s[12:15], s6 offen offset:3072 lds
    s_lshl_b32 s7, s5, 15
    s_add_u32 m0, s7, 12288
    s_add_u32 s6, s61, 12288
    buffer_load_dwordx4 v204, s[12:15], s6 offen offset:0 lds
    buffer_load_dwordx4 v205, s[12:15], s6 offen offset:1024 lds
    buffer_load_dwordx4 v206, s[12:15], s6 offen offset:2048 lds
    buffer_load_dwordx4 v207, s[12:15], s6 offen offset:3072 lds
    v_lshl_add_u32 v2, v3, 2, v5
    v_and_b32 v7, 1, v6
    v_lshrrev_b32 v44, 1, v6
    v_lshlrev_b32 v7, 3, v7
    v_lshl_add_u32 v56, v44, 4, v7
    v_and_b32 v7, 1, v3
    v_lshlrev_b32 v7, 1, v7
    v_lshrrev_b32 v44, 1, v5
    v_add_u32 v7, v7, v44
    v_lshlrev_b32 v7, 1, v7
    s_lshl_b32 s6, s5, 1
    v_xor_b32 v7, s6, v7
    v_lshl_add_u32 v7, v7, 4, v56
    v_lshl_add_u32 v44, v2, 7, v7
    v_add_u32 v47, 0x10000, v44
    v_add_u32 v57, 155648, v44
    v_lshlrev_b32 v45, 10, v6
    v_lshl_add_u32 v45, v3, 4, v45
    v_add_u32 v45, 151552, v45
    v_lshrrev_b32 v46, 2, v1
    v_lshlrev_b32 v46, 6, v46
    v_and_b32 v7, 1, v6
    v_lshl_add_u32 v46, v7, 5, v46
    v_lshrrev_b32 v7, 1, v6
    v_lshl_add_u32 v46, v7, 3, v46
    s_lshl_b32 s6, s5, 10
    s_add_u32 s6, s6, 151552
    v_add_u32 v46, s6, v46
    v_and_b32 v7, 7, v4
    v_lshlrev_b32 v7, 1, v7
    s_lshl_b32 s6, s5, 5
    v_add_u32 v58, s6, v4
    v_lshlrev_b32 v58, 10, v58
    v_add_u32 v59, 0, v3
    v_xor_b32 v59, v59, v7
    v_lshl_add_u32 v24, v59, 4, v58
    v_add_u32 v59, 4, v3
    v_xor_b32 v59, v59, v7
    v_lshl_add_u32 v25, v59, 4, v58
    v_add_u32 v59, 8, v3
    v_xor_b32 v59, v59, v7
    v_lshl_add_u32 v26, v59, 4, v58
    v_add_u32 v59, 12, v3
    v_xor_b32 v59, v59, v7
    v_lshl_add_u32 v27, v59, 4, v58
    v_add_u32 v28, 131072, v31
    v_and_b32 v7, 1, v3
    v_lshl_add_u32 v7, v7, 2, v5
    v_lshlrev_b32 v7, 1, v7
    v_lshl_add_u32 v58, v2, 10, v56
    s_lshl_b32 s6, s5, 8
    v_add_u32 v58, s6, v58
    v_xor_b32 v59, 0, v7
    v_lshl_add_u32 v32, v59, 4, v58
    v_add_u32 v8, 0x10000, v32
    v_xor_b32 v59, 2, v7
    v_lshl_add_u32 v33, v59, 4, v58
    v_add_u32 v9, 0x10000, v33
    v_xor_b32 v59, 4, v7
    v_lshl_add_u32 v34, v59, 4, v58
    v_add_u32 v10, 0x10000, v34
    v_xor_b32 v59, 6, v7
    v_lshl_add_u32 v35, v59, 4, v58
    v_add_u32 v11, 0x10000, v35
    v_xor_b32 v59, 8, v7
    v_lshl_add_u32 v36, v59, 4, v58
    v_add_u32 v12, 0x10000, v36
    v_xor_b32 v59, 10, v7
    v_lshl_add_u32 v37, v59, 4, v58
    v_add_u32 v13, 0x10000, v37
    v_xor_b32 v59, 12, v7
    v_lshl_add_u32 v38, v59, 4, v58
    v_add_u32 v14, 0x10000, v38
    v_xor_b32 v59, 14, v7
    v_lshl_add_u32 v39, v59, 4, v58
    v_add_u32 v15, 0x10000, v39
    v_lshlrev_b32 v58, 1, v3
    v_xor_b32 v58, v58, v4
    v_lshlrev_b32 v58, 4, v58
    v_lshl_add_u32 v192, v3, 13, v58
    v_xor_b32 v193, 0x80, v192
    s_and_b32 s6, s4, 3
    s_lshl_b32 s6, s6, 7
    s_lshl_b32 s7, s5, 5
    s_add_u32 s6, s6, s7
    s_lshl_b32 s6, s6, 13
    s_lshl_b32 s7, s3, 8
    s_add_u32 s52, s6, s7
    v_lshrrev_b32 v58, 5, v1
    v_and_b32 v59, 31, v1
    v_add_u32 v60, 0, v58
    v_lshlrev_b32 v60, 1, v60
    v_xor_b32 v60, v60, v59
    v_lshlrev_b32 v60, 4, v60
    v_lshl_add_u32 v194, v58, 10, v60
    v_add_u32 v60, 2, v58
    v_lshlrev_b32 v60, 1, v60
    v_xor_b32 v60, v60, v59
    v_lshlrev_b32 v60, 4, v60
    v_lshl_add_u32 v195, v58, 10, v60
    v_add_u32 v60, 4, v58
    v_lshlrev_b32 v60, 1, v60
    v_xor_b32 v60, v60, v59
    v_lshlrev_b32 v60, 4, v60
    v_lshl_add_u32 v196, v58, 10, v60
    v_add_u32 v60, 6, v58
    v_lshlrev_b32 v60, 1, v60
    v_xor_b32 v60, v60, v59
    v_lshlrev_b32 v60, 4, v60
    v_lshl_add_u32 v197, v58, 10, v60
    s_lshl_b32 s6, s3, 17
    s_lshl_b32 s7, s5, 15
    s_add_u32 s6, s6, s7
    s_lshr_b32 s7, s4, 2
    s_lshl_b32 s7, s7, 9
    s_add_u32 s53, s6, s7
    s_lshr_b32 s54, s4, 2
    s_lshl_b32 s54, s54, 17
    s_and_b32 s55, s4, 3
    s_lshl_b32 s55, s55, 13
    s_lshl_b32 s6, s5, 12
    v_add_u32 v58, s6, v28
    s_waitcnt vmcnt(26)
    v_lshlrev_b32 v59, 16, v128
    v_lshlrev_b32 v60, 16, v144
    v_and_b32 v61, 0xffff0000, v128
    v_and_b32 v62, 0xffff0000, v144
    v_add_f32 v59, v59, v60
    v_add_f32 v61, v61, v62
    v_cvt_pk_bf16_f32 v64, v59, v61
    v_lshlrev_b32 v59, 16, v129
    v_lshlrev_b32 v60, 16, v145
    v_and_b32 v61, 0xffff0000, v129
    v_and_b32 v62, 0xffff0000, v145
    v_add_f32 v59, v59, v60
    v_add_f32 v61, v61, v62
    v_cvt_pk_bf16_f32 v65, v59, v61
    v_lshlrev_b32 v59, 16, v130
    v_lshlrev_b32 v60, 16, v146
    v_and_b32 v61, 0xffff0000, v130
    v_and_b32 v62, 0xffff0000, v146
    v_add_f32 v59, v59, v60
    v_add_f32 v61, v61, v62
    v_cvt_pk_bf16_f32 v66, v59, v61
    v_lshlrev_b32 v59, 16, v131
    v_lshlrev_b32 v60, 16, v147
    v_and_b32 v61, 0xffff0000, v131
    v_and_b32 v62, 0xffff0000, v147
    v_add_f32 v59, v59, v60
    v_add_f32 v61, v61, v62
    v_cvt_pk_bf16_f32 v67, v59, v61
    ds_write_b128 v58, v[64:67] offset:0
    v_lshlrev_b32 v59, 16, v132
    v_lshlrev_b32 v60, 16, v148
    v_and_b32 v61, 0xffff0000, v132
    v_and_b32 v62, 0xffff0000, v148
    v_add_f32 v59, v59, v60
    v_add_f32 v61, v61, v62
    v_cvt_pk_bf16_f32 v68, v59, v61
    v_lshlrev_b32 v59, 16, v133
    v_lshlrev_b32 v60, 16, v149
    v_and_b32 v61, 0xffff0000, v133
    v_and_b32 v62, 0xffff0000, v149
    v_add_f32 v59, v59, v60
    v_add_f32 v61, v61, v62
    v_cvt_pk_bf16_f32 v69, v59, v61
    v_lshlrev_b32 v59, 16, v134
    v_lshlrev_b32 v60, 16, v150
    v_and_b32 v61, 0xffff0000, v134
    v_and_b32 v62, 0xffff0000, v150
    v_add_f32 v59, v59, v60
    v_add_f32 v61, v61, v62
    v_cvt_pk_bf16_f32 v70, v59, v61
    v_lshlrev_b32 v59, 16, v135
    v_lshlrev_b32 v60, 16, v151
    v_and_b32 v61, 0xffff0000, v135
    v_and_b32 v62, 0xffff0000, v151
    v_add_f32 v59, v59, v60
    v_add_f32 v61, v61, v62
    v_cvt_pk_bf16_f32 v71, v59, v61
    ds_write_b128 v58, v[68:71] offset:1024
    v_lshlrev_b32 v59, 16, v136
    v_lshlrev_b32 v60, 16, v152
    v_and_b32 v61, 0xffff0000, v136
    v_and_b32 v62, 0xffff0000, v152
    v_add_f32 v59, v59, v60
    v_add_f32 v61, v61, v62
    v_cvt_pk_bf16_f32 v72, v59, v61
    v_lshlrev_b32 v59, 16, v137
    v_lshlrev_b32 v60, 16, v153
    v_and_b32 v61, 0xffff0000, v137
    v_and_b32 v62, 0xffff0000, v153
    v_add_f32 v59, v59, v60
    v_add_f32 v61, v61, v62
    v_cvt_pk_bf16_f32 v73, v59, v61
    v_lshlrev_b32 v59, 16, v138
    v_lshlrev_b32 v60, 16, v154
    v_and_b32 v61, 0xffff0000, v138
    v_and_b32 v62, 0xffff0000, v154
    v_add_f32 v59, v59, v60
    v_add_f32 v61, v61, v62
    v_cvt_pk_bf16_f32 v74, v59, v61
    v_lshlrev_b32 v59, 16, v139
    v_lshlrev_b32 v60, 16, v155
    v_and_b32 v61, 0xffff0000, v139
    v_and_b32 v62, 0xffff0000, v155
    v_add_f32 v59, v59, v60
    v_add_f32 v61, v61, v62
    v_cvt_pk_bf16_f32 v75, v59, v61
    ds_write_b128 v58, v[72:75] offset:2048
    v_lshlrev_b32 v59, 16, v140
    v_lshlrev_b32 v60, 16, v156
    v_and_b32 v61, 0xffff0000, v140
    v_and_b32 v62, 0xffff0000, v156
    v_add_f32 v59, v59, v60
    v_add_f32 v61, v61, v62
    v_cvt_pk_bf16_f32 v76, v59, v61
    v_lshlrev_b32 v59, 16, v141
    v_lshlrev_b32 v60, 16, v157
    v_and_b32 v61, 0xffff0000, v141
    v_and_b32 v62, 0xffff0000, v157
    v_add_f32 v59, v59, v60
    v_add_f32 v61, v61, v62
    v_cvt_pk_bf16_f32 v77, v59, v61
    v_lshlrev_b32 v59, 16, v142
    v_lshlrev_b32 v60, 16, v158
    v_and_b32 v61, 0xffff0000, v142
    v_and_b32 v62, 0xffff0000, v158
    v_add_f32 v59, v59, v60
    v_add_f32 v61, v61, v62
    v_cvt_pk_bf16_f32 v78, v59, v61
    v_lshlrev_b32 v59, 16, v143
    v_lshlrev_b32 v60, 16, v159
    v_and_b32 v61, 0xffff0000, v143
    v_and_b32 v62, 0xffff0000, v159
    v_add_f32 v59, v59, v60
    v_add_f32 v61, v61, v62
    v_cvt_pk_bf16_f32 v79, v59, v61
    ds_write_b128 v58, v[76:79] offset:3072
    s_waitcnt lgkmcnt(0)
    s_barrier
    s_lshl_b32 s7, s5, 15
    s_add_u32 m0, s7, 16384
    s_add_u32 s6, s61, 16384
    buffer_load_dwordx4 v200, s[12:15], s6 offen offset:0 lds
    buffer_load_dwordx4 v201, s[12:15], s6 offen offset:1024 lds
    buffer_load_dwordx4 v202, s[12:15], s6 offen offset:2048 lds
    buffer_load_dwordx4 v203, s[12:15], s6 offen offset:3072 lds
    s_lshl_b32 s7, s5, 15
    s_add_u32 m0, s7, 20480
    s_add_u32 s6, s61, 20480
    buffer_load_dwordx4 v204, s[12:15], s6 offen offset:0 lds
    buffer_load_dwordx4 v205, s[12:15], s6 offen offset:1024 lds
    buffer_load_dwordx4 v206, s[12:15], s6 offen offset:2048 lds
    buffer_load_dwordx4 v207, s[12:15], s6 offen offset:3072 lds
    s_lshl_b32 s7, s5, 15
    s_add_u32 m0, s7, 24576
    s_add_u32 s6, s61, 24576
    buffer_load_dwordx4 v200, s[12:15], s6 offen offset:0 lds
    buffer_load_dwordx4 v201, s[12:15], s6 offen offset:1024 lds
    buffer_load_dwordx4 v202, s[12:15], s6 offen offset:2048 lds
    buffer_load_dwordx4 v203, s[12:15], s6 offen offset:3072 lds
    s_lshl_b32 s7, s5, 15
    s_add_u32 m0, s7, 28672
    s_add_u32 s6, s61, 28672
    buffer_load_dwordx4 v204, s[12:15], s6 offen offset:0 lds
    buffer_load_dwordx4 v205, s[12:15], s6 offen offset:1024 lds
    buffer_load_dwordx4 v206, s[12:15], s6 offen offset:2048 lds
    buffer_load_dwordx4 v207, s[12:15], s6 offen offset:3072 lds
    ds_read_b128 v[64:67], v28 offset:0
    ds_read_b128 v[68:71], v28 offset:1024
    ds_read_b128 v[72:75], v28 offset:2048
    ds_read_b128 v[76:79], v28 offset:3072
    ds_read_b128 v[80:83], v28 offset:4096
    ds_read_b128 v[84:87], v28 offset:5120
    ds_read_b128 v[88:91], v28 offset:6144
    ds_read_b128 v[92:95], v28 offset:7168
    ds_read_b128 v[96:99], v28 offset:8192
    ds_read_b128 v[100:103], v28 offset:9216
    ds_read_b128 v[104:107], v28 offset:10240
    ds_read_b128 v[108:111], v28 offset:11264
    ds_read_b128 v[112:115], v28 offset:12288
    ds_read_b128 v[116:119], v28 offset:13312
    ds_read_b128 v[120:123], v28 offset:14336
    ds_read_b128 v[124:127], v28 offset:15360
    s_waitcnt vmcnt(34)
    v_add_f32 v160, v160, v162
    v_add_f32 v164, v164, v166
    v_add_f32 v161, v161, v163
    v_add_f32 v165, v165, v167
    v_add_f32 v160, v160, v164
    v_add_f32 v161, v161, v165
    v_mul_f32 v162, 0xbfb8aa3b, v160
    v_exp_f32 v162, v162
    v_and_b32 v163, 32, v1
    v_lshl_add_u32 v163, v5, 3, v163
    v_add_f32 v162, 1.0, v162
    v_rcp_f32 v162, v162
    v_bfe_u32 v164, v1, 4, 1
    v_lshl_add_u32 v163, v164, 2, v163
    v_add_u32 v163, v163, v6
    v_mul_f32 v160, v160, v162
    v_mul_f32 v160, v160, v161
    v_cvt_pk_bf16_f32 v160, v160, v160
    v_lshlrev_b32 v163, 1, v163
    s_lshl_b32 s6, s5, 7
    s_add_u32 s6, s6, 154624
    v_add_u32 v163, s6, v163
    ds_write_b16 v163, v160
    s_waitcnt vmcnt(16)
    ds_read_b128 v[128:131], v24 offset:0
    ds_read_b128 v[132:135], v25 offset:0
    ds_read_b128 v[136:139], v26 offset:0
    ds_read_b128 v[140:143], v27 offset:0
    ds_read_b128 v[144:147], v24 offset:256
    ds_read_b128 v[148:151], v25 offset:256
    ds_read_b128 v[152:155], v26 offset:256
    ds_read_b128 v[156:159], v27 offset:256
    ds_read_b128 v[160:163], v24 offset:512
    ds_read_b128 v[164:167], v25 offset:512
    ds_read_b128 v[168:171], v26 offset:512
    ds_read_b128 v[172:175], v27 offset:512
    ds_read_b128 v[176:179], v24 offset:768
    ds_read_b128 v[180:183], v25 offset:768
    ds_read_b128 v[184:187], v26 offset:768
    ds_read_b128 v[188:191], v27 offset:768
    s_waitcnt lgkmcnt(15)
    v_mfma_f32_16x16x32_bf16 v[48:51], v[128:131], v[64:67], 0
    s_waitcnt lgkmcnt(14)
    v_mfma_f32_16x16x32_bf16 v[48:51], v[132:135], v[68:71], v[48:51]
    s_waitcnt lgkmcnt(13)
    v_mfma_f32_16x16x32_bf16 v[48:51], v[136:139], v[72:75], v[48:51]
    s_waitcnt lgkmcnt(12)
    v_mfma_f32_16x16x32_bf16 v[48:51], v[140:143], v[76:79], v[48:51]
    s_waitcnt lgkmcnt(11)
    v_mfma_f32_16x16x32_bf16 v[48:51], v[144:147], v[80:83], v[48:51]
    s_waitcnt lgkmcnt(10)
    v_mfma_f32_16x16x32_bf16 v[48:51], v[148:151], v[84:87], v[48:51]
    s_waitcnt lgkmcnt(9)
    v_mfma_f32_16x16x32_bf16 v[48:51], v[152:155], v[88:91], v[48:51]
    s_waitcnt lgkmcnt(8)
    v_mfma_f32_16x16x32_bf16 v[48:51], v[156:159], v[92:95], v[48:51]
    s_waitcnt lgkmcnt(7)
    v_mfma_f32_16x16x32_bf16 v[48:51], v[160:163], v[96:99], v[48:51]
    s_waitcnt lgkmcnt(6)
    v_mfma_f32_16x16x32_bf16 v[48:51], v[164:167], v[100:103], v[48:51]
    s_waitcnt lgkmcnt(5)
    v_mfma_f32_16x16x32_bf16 v[48:51], v[168:171], v[104:107], v[48:51]
    s_waitcnt lgkmcnt(4)
    v_mfma_f32_16x16x32_bf16 v[48:51], v[172:175], v[108:111], v[48:51]
    s_waitcnt lgkmcnt(3)
    v_mfma_f32_16x16x32_bf16 v[48:51], v[176:179], v[112:115], v[48:51]
    s_waitcnt lgkmcnt(2)
    v_mfma_f32_16x16x32_bf16 v[48:51], v[180:183], v[116:119], v[48:51]
    s_waitcnt lgkmcnt(1)
    v_mfma_f32_16x16x32_bf16 v[48:51], v[184:187], v[120:123], v[48:51]
    s_waitcnt lgkmcnt(0)
    v_mfma_f32_16x16x32_bf16 v[48:51], v[188:191], v[124:127], v[48:51]
    s_waitcnt vmcnt(0)
    buffer_load_dwordx4 a[0:3], v192, s[24:27], s52 offen
    s_add_u32 s52, s52, 32768
    buffer_load_dwordx4 a[4:7], v193, s[24:27], s52 offen
    s_add_u32 s52, s52, 32768
    buffer_load_dwordx4 a[8:11], v192, s[24:27], s52 offen
    s_add_u32 s52, s52, 32768
    buffer_load_dwordx4 a[12:15], v193, s[24:27], s52 offen
    s_add_u32 s52, s52, 32768
    buffer_load_dwordx4 a[16:19], v192, s[24:27], s52 offen
    s_add_u32 s52, s52, 32768
    buffer_load_dwordx4 a[20:23], v193, s[24:27], s52 offen
    s_add_u32 s52, s52, 32768
    ds_read_b128 v[128:131], v24 offset:16384
    ds_read_b128 v[132:135], v25 offset:16384
    ds_read_b128 v[136:139], v26 offset:16384
    ds_read_b128 v[140:143], v27 offset:16384
    ds_read_b128 v[144:147], v24 offset:16640
    ds_read_b128 v[148:151], v25 offset:16640
    ds_read_b128 v[152:155], v26 offset:16640
    ds_read_b128 v[156:159], v27 offset:16640
    ds_read_b128 v[160:163], v24 offset:16896
    ds_read_b128 v[164:167], v25 offset:16896
    ds_read_b128 v[168:171], v26 offset:16896
    ds_read_b128 v[172:175], v27 offset:16896
    ds_read_b128 v[176:179], v24 offset:17152
    ds_read_b128 v[180:183], v25 offset:17152
    ds_read_b128 v[184:187], v26 offset:17152
    ds_read_b128 v[188:191], v27 offset:17152
    s_waitcnt lgkmcnt(15)
    v_mfma_f32_16x16x32_bf16 v[52:55], v[128:131], v[64:67], 0
    s_waitcnt lgkmcnt(14)
    v_mfma_f32_16x16x32_bf16 v[52:55], v[132:135], v[68:71], v[52:55]
    s_waitcnt lgkmcnt(13)
    v_mfma_f32_16x16x32_bf16 v[52:55], v[136:139], v[72:75], v[52:55]
    s_waitcnt lgkmcnt(12)
    v_mfma_f32_16x16x32_bf16 v[52:55], v[140:143], v[76:79], v[52:55]
    s_waitcnt lgkmcnt(11)
    v_mfma_f32_16x16x32_bf16 v[52:55], v[144:147], v[80:83], v[52:55]
    s_waitcnt lgkmcnt(10)
    v_mfma_f32_16x16x32_bf16 v[52:55], v[148:151], v[84:87], v[52:55]
    s_waitcnt lgkmcnt(9)
    v_mfma_f32_16x16x32_bf16 v[52:55], v[152:155], v[88:91], v[52:55]
    s_waitcnt lgkmcnt(8)
    v_mfma_f32_16x16x32_bf16 v[52:55], v[156:159], v[92:95], v[52:55]
    s_waitcnt lgkmcnt(7)
    v_mfma_f32_16x16x32_bf16 v[52:55], v[160:163], v[96:99], v[52:55]
    s_waitcnt lgkmcnt(6)
    v_mfma_f32_16x16x32_bf16 v[52:55], v[164:167], v[100:103], v[52:55]
    s_waitcnt lgkmcnt(5)
    v_mfma_f32_16x16x32_bf16 v[52:55], v[168:171], v[104:107], v[52:55]
    s_waitcnt lgkmcnt(4)
    v_mfma_f32_16x16x32_bf16 v[52:55], v[172:175], v[108:111], v[52:55]
    s_waitcnt lgkmcnt(3)
    v_mfma_f32_16x16x32_bf16 v[52:55], v[176:179], v[112:115], v[52:55]
    s_waitcnt lgkmcnt(2)
    v_mfma_f32_16x16x32_bf16 v[52:55], v[180:183], v[116:119], v[52:55]
    s_waitcnt lgkmcnt(1)
    v_mfma_f32_16x16x32_bf16 v[52:55], v[184:187], v[120:123], v[52:55]
    s_waitcnt lgkmcnt(0)
    v_mfma_f32_16x16x32_bf16 v[52:55], v[188:191], v[124:127], v[52:55]
    v_lshlrev_b32 v58, 4, v4
    s_lshl_b32 s6, s5, 2
    s_add_u32 s6, s6, 151552
    v_add_u32 v59, s6, v58
    v_add_u32 v58, 151552, v58
    s_nop 4
    v_max3_f32 v60, v48, v49, v50
    v_max3_f32 v60, v60, v51, v52
    v_max3_f32 v60, v60, v53, v54
    v_max_f32 v60, v60, v55
    v_mov_b32 v61, v60
    s_nop 1
    v_permlane16_swap_b32 v60, v61
    s_nop 1
    v_max_f32 v60, v60, v61
    v_mov_b32 v61, v60
    s_nop 1
    v_permlane32_swap_b32 v60, v61
    s_nop 1
    v_max_f32 v60, v60, v61
    ds_write_b32 v59, v60
    s_waitcnt lgkmcnt(0)
    s_barrier
    ds_read_b128 v[128:131], v58
    s_waitcnt lgkmcnt(0)
    v_max3_f32 v60, v128, v129, v130
    v_max_f32 v60, v60, v131
    buffer_load_dwordx4 a[24:27], v192, s[24:27], s52 offen
    s_add_u32 s52, s52, 32768
    buffer_load_dwordx4 a[28:31], v193, s[24:27], s52 offen
    s_add_u32 s52, s52, 32768
    buffer_load_dwordx4 a[32:35], v194, s[28:31], s53 offen
    s_add_u32 s53, s53, 2048
    buffer_load_dwordx4 a[36:39], v195, s[28:31], s53 offen
    s_add_u32 s53, s53, 2048
    v_sub_f32 v48, v48, v60
    v_sub_f32 v49, v49, v60
    v_sub_f32 v50, v50, v60
    v_sub_f32 v51, v51, v60
    v_sub_f32 v52, v52, v60
    v_sub_f32 v53, v53, v60
    v_sub_f32 v54, v54, v60
    v_sub_f32 v55, v55, v60
    v_exp_f32 v48, v48
    v_exp_f32 v49, v49
    v_exp_f32 v50, v50
    v_exp_f32 v51, v51
    v_exp_f32 v52, v52
    v_exp_f32 v53, v53
    v_exp_f32 v54, v54
    v_exp_f32 v55, v55
    s_nop 0
    v_add_f32 v61, v48, v49
    v_add_f32 v62, v50, v51
    v_add_f32 v63, v52, v53
    v_add_f32 v128, v54, v55
    v_add_f32 v61, v61, v62
    v_add_f32 v63, v63, v128
    v_add_f32 v61, v61, v63
    v_cvt_pk_bf16_f32 v48, v48, v49
    v_cvt_pk_bf16_f32 v49, v50, v51
    v_cvt_pk_bf16_f32 v50, v52, v53
    v_cvt_pk_bf16_f32 v51, v54, v55
    s_lshl_b32 s6, s5, 10
    s_add_u32 s6, s6, 147456
    v_add_u32 v62, s6, v31
    ds_write_b128 v62, v[48:51]
    v_mov_b32 v63, v61
    s_nop 1
    v_permlane16_swap_b32 v61, v63
    s_nop 1
    v_add_f32 v61, v61, v63
    v_mov_b32 v63, v61
    s_nop 1
    v_permlane32_swap_b32 v61, v63
    s_nop 1
    v_add_f32 v61, v61, v63
    ds_write_b32 v59, v61 offset:256
    v_add_u32 v62, 147456, v31
    s_waitcnt lgkmcnt(0)
    s_barrier
    ds_read_b128 v[64:67], v62 offset:0
    ds_read_b128 v[68:71], v62 offset:1024
    ds_read_b128 v[72:75], v62 offset:2048
    ds_read_b128 v[76:79], v62 offset:3072
    ds_read_b128 v[52:55], v58 offset:256
    ds_read_b64_tr_b16 v[128:129], v32 offset:0
    ds_read_b64_tr_b16 v[130:131], v32 offset:16384
    ds_read_b64_tr_b16 v[132:133], v33 offset:0
    ds_read_b64_tr_b16 v[134:135], v33 offset:16384
    ds_read_b64_tr_b16 v[136:137], v34 offset:0
    ds_read_b64_tr_b16 v[138:139], v34 offset:16384
    ds_read_b64_tr_b16 v[140:141], v35 offset:0
    ds_read_b64_tr_b16 v[142:143], v35 offset:16384
    ds_read_b64_tr_b16 v[144:145], v36 offset:0
    ds_read_b64_tr_b16 v[146:147], v36 offset:16384
    ds_read_b64_tr_b16 v[148:149], v37 offset:0
    ds_read_b64_tr_b16 v[150:151], v37 offset:16384
    ds_read_b64_tr_b16 v[152:153], v38 offset:0
    ds_read_b64_tr_b16 v[154:155], v38 offset:16384
    ds_read_b64_tr_b16 v[156:157], v39 offset:0
    ds_read_b64_tr_b16 v[158:159], v39 offset:16384
    ds_read_b64_tr_b16 v[160:161], v32 offset:32768
    ds_read_b64_tr_b16 v[162:163], v32 offset:49152
    ds_read_b64_tr_b16 v[164:165], v33 offset:32768
    ds_read_b64_tr_b16 v[166:167], v33 offset:49152
    ds_read_b64_tr_b16 v[168:169], v34 offset:32768
    ds_read_b64_tr_b16 v[170:171], v34 offset:49152
    ds_read_b64_tr_b16 v[172:173], v35 offset:32768
    ds_read_b64_tr_b16 v[174:175], v35 offset:49152
    ds_read_b64_tr_b16 v[176:177], v36 offset:32768
    ds_read_b64_tr_b16 v[178:179], v36 offset:49152
    ds_read_b64_tr_b16 v[180:181], v37 offset:32768
    ds_read_b64_tr_b16 v[182:183], v37 offset:49152
    ds_read_b64_tr_b16 v[184:185], v38 offset:32768
    ds_read_b64_tr_b16 v[186:187], v38 offset:49152
    ds_read_b64_tr_b16 v[188:189], v39 offset:32768
    ds_read_b64_tr_b16 v[190:191], v39 offset:49152
    s_waitcnt lgkmcnt(15)
    v_mfma_f32_16x16x32_bf16 v[80:83], v[128:131], v[64:67], 0
    s_waitcnt lgkmcnt(15)
    v_mfma_f32_16x16x32_bf16 v[84:87], v[132:135], v[64:67], 0
    s_waitcnt lgkmcnt(15)
    v_mfma_f32_16x16x32_bf16 v[88:91], v[136:139], v[64:67], 0
    s_waitcnt lgkmcnt(15)
    v_mfma_f32_16x16x32_bf16 v[92:95], v[140:143], v[64:67], 0
    s_waitcnt lgkmcnt(15)
    v_mfma_f32_16x16x32_bf16 v[96:99], v[144:147], v[64:67], 0
    s_waitcnt lgkmcnt(15)
    v_mfma_f32_16x16x32_bf16 v[100:103], v[148:151], v[64:67], 0
    s_waitcnt lgkmcnt(15)
    v_mfma_f32_16x16x32_bf16 v[104:107], v[152:155], v[64:67], 0
    s_waitcnt lgkmcnt(15)
    v_mfma_f32_16x16x32_bf16 v[108:111], v[156:159], v[64:67], 0
    ds_read_b64_tr_b16 v[128:129], v8 offset:0
    ds_read_b64_tr_b16 v[130:131], v8 offset:16384
    ds_read_b64_tr_b16 v[132:133], v9 offset:0
    ds_read_b64_tr_b16 v[134:135], v9 offset:16384
    ds_read_b64_tr_b16 v[136:137], v10 offset:0
    ds_read_b64_tr_b16 v[138:139], v10 offset:16384
    ds_read_b64_tr_b16 v[140:141], v11 offset:0
    ds_read_b64_tr_b16 v[142:143], v11 offset:16384
    ds_read_b64_tr_b16 v[144:145], v12 offset:0
    ds_read_b64_tr_b16 v[146:147], v12 offset:16384
    ds_read_b64_tr_b16 v[148:149], v13 offset:0
    ds_read_b64_tr_b16 v[150:151], v13 offset:16384
    ds_read_b64_tr_b16 v[152:153], v14 offset:0
    ds_read_b64_tr_b16 v[154:155], v14 offset:16384
    ds_read_b64_tr_b16 v[156:157], v15 offset:0
    ds_read_b64_tr_b16 v[158:159], v15 offset:16384
    s_waitcnt lgkmcnt(15)
    v_mfma_f32_16x16x32_bf16 v[80:83], v[160:163], v[68:71], v[80:83]
    s_waitcnt lgkmcnt(15)
    v_mfma_f32_16x16x32_bf16 v[84:87], v[164:167], v[68:71], v[84:87]
    s_waitcnt lgkmcnt(15)
    v_mfma_f32_16x16x32_bf16 v[88:91], v[168:171], v[68:71], v[88:91]
    s_waitcnt lgkmcnt(15)
    v_mfma_f32_16x16x32_bf16 v[92:95], v[172:175], v[68:71], v[92:95]
    s_waitcnt lgkmcnt(15)
    v_mfma_f32_16x16x32_bf16 v[96:99], v[176:179], v[68:71], v[96:99]
    s_waitcnt lgkmcnt(15)
    v_mfma_f32_16x16x32_bf16 v[100:103], v[180:183], v[68:71], v[100:103]
    s_waitcnt lgkmcnt(15)
    v_mfma_f32_16x16x32_bf16 v[104:107], v[184:187], v[68:71], v[104:107]
    s_waitcnt lgkmcnt(15)
    v_mfma_f32_16x16x32_bf16 v[108:111], v[188:191], v[68:71], v[108:111]
    ds_read_b64_tr_b16 v[160:161], v8 offset:32768
    ds_read_b64_tr_b16 v[162:163], v8 offset:49152
    ds_read_b64_tr_b16 v[164:165], v9 offset:32768
    ds_read_b64_tr_b16 v[166:167], v9 offset:49152
    ds_read_b64_tr_b16 v[168:169], v10 offset:32768
    ds_read_b64_tr_b16 v[170:171], v10 offset:49152
    ds_read_b64_tr_b16 v[172:173], v11 offset:32768
    ds_read_b64_tr_b16 v[174:175], v11 offset:49152
    ds_read_b64_tr_b16 v[176:177], v12 offset:32768
    ds_read_b64_tr_b16 v[178:179], v12 offset:49152
    ds_read_b64_tr_b16 v[180:181], v13 offset:32768
    ds_read_b64_tr_b16 v[182:183], v13 offset:49152
    ds_read_b64_tr_b16 v[184:185], v14 offset:32768
    ds_read_b64_tr_b16 v[186:187], v14 offset:49152
    ds_read_b64_tr_b16 v[188:189], v15 offset:32768
    ds_read_b64_tr_b16 v[190:191], v15 offset:49152
    s_waitcnt lgkmcnt(15)
    v_mfma_f32_16x16x32_bf16 v[80:83], v[128:131], v[72:75], v[80:83]
    s_waitcnt lgkmcnt(15)
    v_mfma_f32_16x16x32_bf16 v[84:87], v[132:135], v[72:75], v[84:87]
    s_waitcnt lgkmcnt(15)
    v_mfma_f32_16x16x32_bf16 v[88:91], v[136:139], v[72:75], v[88:91]
    s_waitcnt lgkmcnt(15)
    v_mfma_f32_16x16x32_bf16 v[92:95], v[140:143], v[72:75], v[92:95]
    s_waitcnt lgkmcnt(15)
    v_mfma_f32_16x16x32_bf16 v[96:99], v[144:147], v[72:75], v[96:99]
    s_waitcnt lgkmcnt(15)
    v_mfma_f32_16x16x32_bf16 v[100:103], v[148:151], v[72:75], v[100:103]
    s_waitcnt lgkmcnt(15)
    v_mfma_f32_16x16x32_bf16 v[104:107], v[152:155], v[72:75], v[104:107]
    s_waitcnt lgkmcnt(15)
    v_mfma_f32_16x16x32_bf16 v[108:111], v[156:159], v[72:75], v[108:111]
    s_waitcnt lgkmcnt(14)
    v_mfma_f32_16x16x32_bf16 v[80:83], v[160:163], v[76:79], v[80:83]
    s_waitcnt lgkmcnt(12)
    v_mfma_f32_16x16x32_bf16 v[84:87], v[164:167], v[76:79], v[84:87]
    s_waitcnt lgkmcnt(10)
    v_mfma_f32_16x16x32_bf16 v[88:91], v[168:171], v[76:79], v[88:91]
    s_waitcnt lgkmcnt(8)
    v_mfma_f32_16x16x32_bf16 v[92:95], v[172:175], v[76:79], v[92:95]
    s_waitcnt lgkmcnt(6)
    v_mfma_f32_16x16x32_bf16 v[96:99], v[176:179], v[76:79], v[96:99]
    s_waitcnt lgkmcnt(4)
    v_mfma_f32_16x16x32_bf16 v[100:103], v[180:183], v[76:79], v[100:103]
    s_waitcnt lgkmcnt(2)
    v_mfma_f32_16x16x32_bf16 v[104:107], v[184:187], v[76:79], v[104:107]
    s_waitcnt lgkmcnt(0)
    v_mfma_f32_16x16x32_bf16 v[108:111], v[188:191], v[76:79], v[108:111]
    s_barrier
    v_add_f32 v52, v52, v53
    v_add_f32 v54, v54, v55
    v_add_f32 v61, v52, v54
    s_mov_b32 s61, 0xfffffffe
    s_lshr_b32 s7, s57, 5
    s_lshl_b32 s6, s58, 6
    s_add_u32 s6, s6, s7
    s_lshl_b32 s6, s6, 2
    s_and_b32 s7, s57, 3
    s_add_u32 s6, s6, s7
    s_lshl_b32 s6, s6, 3
    s_bfe_u32 s7, s57, 0x30002
    s_add_u32 s6, s6, s7
    s_lshl_b32 s6, s6, 3
    s_add_u32 s6, s6, 589824
    v_lshlrev_b32 v58, 10, v4
    v_min_u32 v60, s61, v60
    v_min_u32 v61, s61, v61
    s_lshl_b32 s7, s58, 6
    s_add_u32 s7, s7, s5
    s_lshl_b32 s7, s7, 7
    s_add_u32 s7, s7, s57
    s_lshl_b32 s7, s7, 8
    s_add_u32 s7, s7, 4194304
    v_lshlrev_b32 v59, 17, v4
    v_lshl_add_u32 v59, v3, 4, v59
    v_cvt_pk_bf16_f32 v80, v80, v81
    v_cvt_pk_bf16_f32 v81, v82, v83
    v_cvt_pk_bf16_f32 v82, v84, v85
    v_cvt_pk_bf16_f32 v83, v86, v87
    v_min_u32 v80, s61, v80
    v_min_u32 v81, s61, v81
    v_min_u32 v82, s61, v82
    v_min_u32 v83, s61, v83
    buffer_store_dwordx4 v[80:83], v59, s[36:39], s7 offen offset:0 sc1
    v_cvt_pk_bf16_f32 v88, v88, v89
    v_cvt_pk_bf16_f32 v89, v90, v91
    v_cvt_pk_bf16_f32 v90, v92, v93
    v_cvt_pk_bf16_f32 v91, v94, v95
    v_min_u32 v88, s61, v88
    v_min_u32 v89, s61, v89
    v_min_u32 v90, s61, v90
    v_min_u32 v91, s61, v91
    buffer_store_dwordx4 v[88:91], v59, s[36:39], s7 offen offset:64 sc1
    v_cvt_pk_bf16_f32 v96, v96, v97
    v_cvt_pk_bf16_f32 v97, v98, v99
    v_cvt_pk_bf16_f32 v98, v100, v101
    v_cvt_pk_bf16_f32 v99, v102, v103
    v_min_u32 v96, s61, v96
    v_min_u32 v97, s61, v97
    v_min_u32 v98, s61, v98
    v_min_u32 v99, s61, v99
    buffer_store_dwordx4 v[96:99], v59, s[36:39], s7 offen offset:128 sc1
    v_cvt_pk_bf16_f32 v104, v104, v105
    v_cvt_pk_bf16_f32 v105, v106, v107
    v_cvt_pk_bf16_f32 v106, v108, v109
    v_cvt_pk_bf16_f32 v107, v110, v111
    v_min_u32 v104, s61, v104
    v_min_u32 v105, s61, v105
    v_min_u32 v106, s61, v106
    v_min_u32 v107, s61, v107
    buffer_store_dwordx4 v[104:107], v59, s[36:39], s7 offen offset:192 sc1
    s_cmp_lg_u32 s5, 0
    s_cbranch_scc1 NOSTAT
    v_cmp_gt_u32 vcc, 16, v1
    s_and_saveexec_b64 s[62:63], vcc
    buffer_store_dwordx2 v[60:61], v58, s[36:39], s6 offen sc1
    s_mov_b64 exec, s[62:63]
NOSTAT:
    buffer_load_dwordx4 a[40:43], v196, s[28:31], s53 offen
    s_add_u32 s53, s53, 2048
    buffer_load_dwordx4 a[44:47], v197, s[28:31], s53 offen
    s_add_u32 s53, s53, 2048
    buffer_load_dwordx4 a[48:51], v194, s[28:31], s53 offen
    s_add_u32 s53, s53, 2048
    buffer_load_dwordx4 a[52:55], v195, s[28:31], s53 offen
    s_add_u32 s53, s53, 2048
    buffer_load_dwordx4 a[56:59], v196, s[28:31], s53 offen
    s_add_u32 s53, s53, 2048
    buffer_load_dwordx4 a[60:63], v197, s[28:31], s53 offen
    s_add_u32 s53, s53, 2048
    buffer_load_dwordx4 a[64:67], v194, s[28:31], s53 offen
    s_add_u32 s53, s53, 2048
    buffer_load_dwordx4 a[68:71], v195, s[28:31], s53 offen
    s_add_u32 s53, s53, 2048
    buffer_load_dwordx4 a[72:75], v196, s[28:31], s53 offen
    s_add_u32 s53, s53, 2048
    buffer_load_dwordx4 a[76:79], v197, s[28:31], s53 offen
    s_add_u32 s53, s53, 2048
    buffer_load_dwordx4 a[80:83], v194, s[28:31], s53 offen
    s_add_u32 s53, s53, 2048
    buffer_load_dwordx4 a[84:87], v195, s[28:31], s53 offen
    s_add_u32 s53, s53, 2048
    buffer_load_dwordx4 a[88:91], v196, s[28:31], s53 offen
    s_add_u32 s53, s53, 2048
    buffer_load_dwordx4 a[92:95], v197, s[28:31], s53 offen
    s_add_u32 s53, s53, 2048
    s_lshl_b32 s6, s5, 13
    v_add_u32 v58, s6, v31
    s_lshl_b32 s6, s5, 14
    s_add_u32 s6, s6, 32768
    v_add_u32 v59, s6, v31
    s_waitcnt vmcnt(0)
    ds_write_b128 v58, a[0:3] offset:0
    ds_write_b128 v58, a[4:7] offset:1024
    ds_write_b128 v58, a[8:11] offset:2048
    ds_write_b128 v58, a[12:15] offset:3072
    ds_write_b128 v58, a[16:19] offset:4096
    ds_write_b128 v58, a[20:23] offset:5120
    ds_write_b128 v58, a[24:27] offset:6144
    ds_write_b128 v58, a[28:31] offset:7168
    ds_write_b128 v59, a[32:35] offset:0
    ds_write_b128 v59, a[36:39] offset:1024
    ds_write_b128 v59, a[40:43] offset:2048
    ds_write_b128 v59, a[44:47] offset:3072
    ds_write_b128 v59, a[48:51] offset:4096
    ds_write_b128 v59, a[52:55] offset:5120
    ds_write_b128 v59, a[56:59] offset:6144
    ds_write_b128 v59, a[60:63] offset:7168
    ds_write_b128 v59, a[64:67] offset:8192
    ds_write_b128 v59, a[68:71] offset:9216
    ds_write_b128 v59, a[72:75] offset:10240
    ds_write_b128 v59, a[76:79] offset:11264
    ds_write_b128 v59, a[80:83] offset:12288
    ds_write_b128 v59, a[84:87] offset:13312
    ds_write_b128 v59, a[88:91] offset:14336
    ds_write_b128 v59, a[92:95] offset:15360
    v_lshlrev_b32 v58, 7, v6
    v_lshl_add_u32 v58, v3, 4, v58
    v_add_u32 v58, 154624, v58
    ds_read_b128 v[64:67], v58
    ds_read_b128 v[68:71], v58 offset:64
    ds_read_b64_tr_b16 v[72:73], v57 offset:0
    ds_read_b64_tr_b16 v[74:75], v57 offset:2048
    ds_read_b64_tr_b16 v[76:77], v57 offset:4096
    ds_read_b64_tr_b16 v[78:79], v57 offset:6144
    s_lshl_b32 s6, s60, 1
    s_lshr_b32 s7, s5, 1
    s_add_u32 s6, s6, s7
    s_mul_i32 s6, s6, 19968
    s_add_u32 s7, s59, 128
    s_lshl_b32 s7, s7, 7
    s_add_u32 s6, s6, s7
    s_and_b32 s7, s5, 1
    s_lshl_b32 s7, s7, 6
    s_add_u32 s6, s6, s7
    s_add_u32 s6, s6, 1048576
    s_mov_b32 s7, 319488
    v_mul_lo_u32 v63, v4, s7
    v_lshl_add_u32 v63, v3, 4, v63
    s_waitcnt lgkmcnt(0)
    v_mfma_f32_16x16x32_bf16 v[80:83], v[72:75], v[64:67], 0
    v_mfma_f32_16x16x32_bf16 v[80:83], v[76:79], v[68:71], v[80:83]
    v_cmp_gt_u32 vcc, 4, v4
    s_and_saveexec_b64 s[62:63], vcc
    s_nop 7
    v_min_u32 v80, s61, v80
    v_min_u32 v81, s61, v81
    v_min_u32 v82, s61, v82
    v_min_u32 v83, s61, v83
    buffer_store_dwordx4 v[80:83], v63, s[36:39], s6 offen sc1
    s_mov_b64 exec, s[62:63]
    s_lshl_b32 s6, s5, 2
    s_add_u32 s6, s6, 0
    v_xor_b32 v58, s6, v7
    v_lshl_add_u32 v58, v58, 4, v56
    v_lshl_add_u32 v24, v2, 8, v58
    s_lshl_b32 s6, s5, 2
    s_add_u32 s6, s6, 2
    v_xor_b32 v58, s6, v7
    v_lshl_add_u32 v58, v58, 4, v56
    v_lshl_add_u32 v25, v2, 8, v58
    s_lshl_b32 s6, s5, 3
    s_add_u32 s6, s6, 0
    s_and_b32 s7, s6, 15
    s_and_b32 s6, s6, 16
    v_xor_b32 v58, s7, v7
    v_add_u32 v58, s6, v58
    v_lshl_add_u32 v58, v58, 4, v56
    v_lshl_add_u32 v58, v2, 9, v58
    v_add_u32 v26, 32768, v58
    s_lshl_b32 s6, s5, 3
    s_add_u32 s6, s6, 2
    s_and_b32 s7, s6, 15
    s_and_b32 s6, s6, 16
    v_xor_b32 v58, s7, v7
    v_add_u32 v58, s6, v58
    v_lshl_add_u32 v58, v58, 4, v56
    v_lshl_add_u32 v58, v2, 9, v58
    v_add_u32 v27, 32768, v58
    s_lshl_b32 s6, s5, 3
    s_add_u32 s6, s6, 4
    s_and_b32 s7, s6, 15
    s_and_b32 s6, s6, 16
    v_xor_b32 v58, s7, v7
    v_add_u32 v58, s6, v58
    v_lshl_add_u32 v58, v58, 4, v56
    v_lshl_add_u32 v58, v2, 9, v58
    v_add_u32 v28, 32768, v58
    s_lshl_b32 s6, s5, 3
    s_add_u32 s6, s6, 6
    s_and_b32 s7, s6, 15
    s_and_b32 s6, s6, 16
    v_xor_b32 v58, s7, v7
    v_add_u32 v58, s6, v58
    v_lshl_add_u32 v58, v58, 4, v56
    v_lshl_add_u32 v58, v2, 9, v58
    v_add_u32 v29, 32768, v58
    v_lshlrev_b32 v30, 8, v6
    v_lshl_add_u32 v30, v3, 4, v30
    v_add_u32 v30, 152576, v30
    s_lshl_b32 s54, s3, 2
    s_and_b32 s7, s4, 3
    s_add_u32 s54, s54, s7
    s_lshl_b32 s54, s54, 2
    s_add_u32 s54, s54, s5
    s_lshl_b32 s54, s54, 13
    s_add_u32 s54, s54, 4194304
    s_add_u32 s55, s54, 4096
    s_lshl_b32 s6, s3, 2
    s_add_u32 s6, s6, s5
    s_lshl_b32 s6, s6, 8
    s_add_u32 s6, s6, 589824
    v_lshlrev_b32 v58, 6, v3
    s_mov_b32 s7, 40000
    buffer_load_dwordx4 v[64:67], v58, s[36:39], s6 offen offset:0 sc1
    buffer_load_dwordx4 v[68:71], v58, s[36:39], s6 offen offset:16 sc1
    buffer_load_dwordx4 v[72:75], v58, s[36:39], s6 offen offset:32 sc1
    buffer_load_dwordx4 v[76:79], v58, s[36:39], s6 offen offset:48 sc1
    s_waitcnt lgkmcnt(0)
    s_barrier
    ds_read_b64_tr_b16 v[128:129], v24 offset:0
    ds_read_b64_tr_b16 v[130:131], v24 offset:4096
    ds_read_b64_tr_b16 v[132:133], v25 offset:0
    ds_read_b64_tr_b16 v[134:135], v25 offset:4096
    ds_read_b64_tr_b16 v[136:137], v24 offset:8192
    ds_read_b64_tr_b16 v[138:139], v24 offset:12288
    ds_read_b64_tr_b16 v[140:141], v25 offset:8192
    ds_read_b64_tr_b16 v[142:143], v25 offset:12288
    ds_read_b64_tr_b16 v[144:145], v24 offset:16384
    ds_read_b64_tr_b16 v[146:147], v24 offset:20480
    ds_read_b64_tr_b16 v[148:149], v25 offset:16384
    ds_read_b64_tr_b16 v[150:151], v25 offset:20480
    ds_read_b64_tr_b16 v[152:153], v24 offset:24576
    ds_read_b64_tr_b16 v[154:155], v24 offset:28672
    ds_read_b64_tr_b16 v[156:157], v25 offset:24576
    ds_read_b64_tr_b16 v[158:159], v25 offset:28672
    ds_read_b64_tr_b16 v[160:161], v26 offset:0
    ds_read_b64_tr_b16 v[162:163], v26 offset:8192
    ds_read_b64_tr_b16 v[164:165], v27 offset:0
    ds_read_b64_tr_b16 v[166:167], v27 offset:8192
    ds_read_b64_tr_b16 v[168:169], v28 offset:0
    ds_read_b64_tr_b16 v[170:171], v28 offset:8192
    ds_read_b64_tr_b16 v[172:173], v29 offset:0
    ds_read_b64_tr_b16 v[174:175], v29 offset:8192
    ds_read_b64_tr_b16 v[176:177], v26 offset:16384
    ds_read_b64_tr_b16 v[178:179], v26 offset:24576
    ds_read_b64_tr_b16 v[180:181], v27 offset:16384
    ds_read_b64_tr_b16 v[182:183], v27 offset:24576
    ds_read_b64_tr_b16 v[184:185], v28 offset:16384
    ds_read_b64_tr_b16 v[186:187], v28 offset:24576
    ds_read_b64_tr_b16 v[188:189], v29 offset:16384
    ds_read_b64_tr_b16 v[190:191], v29 offset:24576
    ds_read_b64_tr_b16 v[192:193], v26 offset:32768
    ds_read_b64_tr_b16 v[194:195], v26 offset:40960
    ds_read_b64_tr_b16 v[196:197], v27 offset:32768
    ds_read_b64_tr_b16 v[198:199], v27 offset:40960
    ds_read_b64_tr_b16 v[200:201], v28 offset:32768
    ds_read_b64_tr_b16 v[202:203], v28 offset:40960
    ds_read_b64_tr_b16 v[204:205], v29 offset:32768
    ds_read_b64_tr_b16 v[206:207], v29 offset:40960
    ds_read_b64_tr_b16 v[208:209], v26 offset:49152
    ds_read_b64_tr_b16 v[210:211], v26 offset:57344
    ds_read_b64_tr_b16 v[212:213], v27 offset:49152
    ds_read_b64_tr_b16 v[214:215], v27 offset:57344
    ds_read_b64_tr_b16 v[216:217], v28 offset:49152
    ds_read_b64_tr_b16 v[218:219], v28 offset:57344
    ds_read_b64_tr_b16 v[220:221], v29 offset:49152
    ds_read_b64_tr_b16 v[222:223], v29 offset:57344
    s_waitcnt vmcnt(0)
    v_max3_u32 v59, v64, v65, v66
    v_max3_u32 v59, v59, v67, v68
    v_max3_u32 v59, v59, v69, v70
    v_max3_u32 v59, v59, v71, v72
    v_max3_u32 v59, v59, v73, v74
    v_max3_u32 v59, v59, v75, v76
    v_max3_u32 v59, v59, v77, v78
    v_max_u32 v59, v59, v79
    v_cmp_eq_u32 vcc, -1, v59
    s_cbranch_vccz E2S_DONE
E2S_POLL:
    buffer_load_dwordx4 v[64:67], v58, s[36:39], s6 offen offset:0 sc1
    buffer_load_dwordx4 v[68:71], v58, s[36:39], s6 offen offset:16 sc1
    buffer_load_dwordx4 v[72:75], v58, s[36:39], s6 offen offset:32 sc1
    buffer_load_dwordx4 v[76:79], v58, s[36:39], s6 offen offset:48 sc1
    s_waitcnt vmcnt(0)
    v_max3_u32 v59, v64, v65, v66
    v_max3_u32 v59, v59, v67, v68
    v_max3_u32 v59, v59, v69, v70
    v_max3_u32 v59, v59, v71, v72
    v_max3_u32 v59, v59, v73, v74
    v_max3_u32 v59, v59, v75, v76
    v_max3_u32 v59, v59, v77, v78
    v_max_u32 v59, v59, v79
    v_cmp_eq_u32 vcc, -1, v59
    s_cbranch_vccz E2S_DONE
    s_sub_u32 s7, s7, 1
    s_cmp_eq_u32 s7, 0
    s_cbranch_scc1 E2S_DONE
    s_sleep 1
    s_branch E2S_POLL
E2S_DONE:
    s_mov_b32 s7, 40000
E2P_POLL:
    buffer_load_dwordx4 v[80:83], v31, s[36:39], s54 offen offset:0 sc1
    buffer_load_dwordx4 v[84:87], v31, s[36:39], s54 offen offset:1024 sc1
    buffer_load_dwordx4 v[88:91], v31, s[36:39], s54 offen offset:2048 sc1
    buffer_load_dwordx4 v[92:95], v31, s[36:39], s54 offen offset:3072 sc1
    buffer_load_dwordx4 v[96:99], v31, s[36:39], s55 offen offset:0 sc1
    buffer_load_dwordx4 v[100:103], v31, s[36:39], s55 offen offset:1024 sc1
    buffer_load_dwordx4 v[104:107], v31, s[36:39], s55 offen offset:2048 sc1
    buffer_load_dwordx4 v[108:111], v31, s[36:39], s55 offen offset:3072 sc1
E2P_MID:
    v_max3_f32 v59, v64, v66, v68
    v_max3_f32 v59, v59, v70, v72
    v_max3_f32 v59, v59, v74, v76
    v_max_f32 v59, v59, v78
    v_mov_b32 v60, v59
    s_nop 1
    v_permlane16_swap_b32 v59, v60
    s_nop 1
    v_max_f32 v59, v59, v60
    v_mov_b32 v60, v59
    s_nop 1
    v_permlane32_swap_b32 v59, v60
    s_nop 1
    v_max_f32 v59, v59, v60
    v_sub_f32 v112, v64, v59
    v_sub_f32 v113, v66, v59
    v_sub_f32 v114, v68, v59
    v_sub_f32 v115, v70, v59
    v_sub_f32 v116, v72, v59
    v_sub_f32 v117, v74, v59
    v_sub_f32 v118, v76, v59
    v_sub_f32 v119, v78, v59
    v_exp_f32 v112, v112
    v_exp_f32 v113, v113
    v_exp_f32 v114, v114
    v_exp_f32 v115, v115
    v_exp_f32 v116, v116
    v_exp_f32 v117, v117
    v_exp_f32 v118, v118
    v_exp_f32 v119, v119
    s_nop 0
    v_mul_f32 v60, v112, v65
    v_fmac_f32 v60, v113, v67
    v_fmac_f32 v60, v114, v69
    v_fmac_f32 v60, v115, v71
    v_fmac_f32 v60, v116, v73
    v_fmac_f32 v60, v117, v75
    v_fmac_f32 v60, v118, v77
    v_fmac_f32 v60, v119, v79
    v_mov_b32 v61, v60
    s_nop 1
    v_permlane16_swap_b32 v60, v61
    s_nop 1
    v_add_f32 v60, v60, v61
    v_mov_b32 v61, v60
    s_nop 1
    v_permlane32_swap_b32 v60, v61
    s_nop 1
    v_add_f32 v60, v60, v61
    v_rcp_f32 v60, v60
    s_nop 0
    v_mul_f32 v112, v112, v60
    v_mul_f32 v113, v113, v60
    v_mul_f32 v114, v114, v60
    v_mul_f32 v115, v115, v60
    v_mul_f32 v116, v116, v60
    v_mul_f32 v117, v117, v60
    v_mul_f32 v118, v118, v60
    v_mul_f32 v119, v119, v60
    s_waitcnt vmcnt(0)
    v_max3_u32 v59, v80, v81, v82
    v_max3_u32 v59, v59, v83, v84
    v_max3_u32 v59, v59, v85, v86
    v_max3_u32 v59, v59, v87, v88
    v_max3_u32 v59, v59, v89, v90
    v_max3_u32 v59, v59, v91, v92
    v_max3_u32 v59, v59, v93, v94
    v_max3_u32 v59, v59, v95, v96
    v_max3_u32 v59, v59, v97, v98
    v_max3_u32 v59, v59, v99, v100
    v_max3_u32 v59, v59, v101, v102
    v_max3_u32 v59, v59, v103, v104
    v_max3_u32 v59, v59, v105, v106
    v_max3_u32 v59, v59, v107, v108
    v_max3_u32 v59, v59, v109, v110
    v_max_u32 v59, v59, v111
    v_cmp_eq_u32 vcc, -1, v59
    s_cbranch_vccz E2P_DONE
    s_sub_u32 s7, s7, 1
    s_cmp_eq_u32 s7, 0
    s_cbranch_scc1 E2P_DONE
    s_branch E2P_POLL
E2P_DONE:
    v_lshlrev_b32 v59, 16, v80
    v_and_b32 v60, 0xffff0000, v80
    v_mul_f32 v120, v112, v59
    v_mul_f32 v121, v112, v60
    v_lshlrev_b32 v59, 16, v81
    v_and_b32 v60, 0xffff0000, v81
    v_mul_f32 v122, v112, v59
    v_mul_f32 v123, v112, v60
    v_lshlrev_b32 v59, 16, v82
    v_and_b32 v60, 0xffff0000, v82
    v_mul_f32 v124, v112, v59
    v_mul_f32 v125, v112, v60
    v_lshlrev_b32 v59, 16, v83
    v_and_b32 v60, 0xffff0000, v83
    v_mul_f32 v126, v112, v59
    v_mul_f32 v127, v112, v60
    v_lshlrev_b32 v59, 16, v84
    v_and_b32 v60, 0xffff0000, v84
    v_fmac_f32 v120, v113, v59
    v_fmac_f32 v121, v113, v60
    v_lshlrev_b32 v59, 16, v85
    v_and_b32 v60, 0xffff0000, v85
    v_fmac_f32 v122, v113, v59
    v_fmac_f32 v123, v113, v60
    v_lshlrev_b32 v59, 16, v86
    v_and_b32 v60, 0xffff0000, v86
    v_fmac_f32 v124, v113, v59
    v_fmac_f32 v125, v113, v60
    v_lshlrev_b32 v59, 16, v87
    v_and_b32 v60, 0xffff0000, v87
    v_fmac_f32 v126, v113, v59
    v_fmac_f32 v127, v113, v60
    v_lshlrev_b32 v59, 16, v88
    v_and_b32 v60, 0xffff0000, v88
    v_fmac_f32 v120, v114, v59
    v_fmac_f32 v121, v114, v60
    v_lshlrev_b32 v59, 16, v89
    v_and_b32 v60, 0xffff0000, v89
    v_fmac_f32 v122, v114, v59
    v_fmac_f32 v123, v114, v60
    v_lshlrev_b32 v59, 16, v90
    v_and_b32 v60, 0xffff0000, v90
    v_fmac_f32 v124, v114, v59
    v_fmac_f32 v125, v114, v60
    v_lshlrev_b32 v59, 16, v91
    v_and_b32 v60, 0xffff0000, v91
    v_fmac_f32 v126, v114, v59
    v_fmac_f32 v127, v114, v60
    v_lshlrev_b32 v59, 16, v92
    v_and_b32 v60, 0xffff0000, v92
    v_fmac_f32 v120, v115, v59
    v_fmac_f32 v121, v115, v60
    v_lshlrev_b32 v59, 16, v93
    v_and_b32 v60, 0xffff0000, v93
    v_fmac_f32 v122, v115, v59
    v_fmac_f32 v123, v115, v60
    v_lshlrev_b32 v59, 16, v94
    v_and_b32 v60, 0xffff0000, v94
    v_fmac_f32 v124, v115, v59
    v_fmac_f32 v125, v115, v60
    v_lshlrev_b32 v59, 16, v95
    v_and_b32 v60, 0xffff0000, v95
    v_fmac_f32 v126, v115, v59
    v_fmac_f32 v127, v115, v60
    v_lshlrev_b32 v59, 16, v96
    v_and_b32 v60, 0xffff0000, v96
    v_fmac_f32 v120, v116, v59
    v_fmac_f32 v121, v116, v60
    v_lshlrev_b32 v59, 16, v97
    v_and_b32 v60, 0xffff0000, v97
    v_fmac_f32 v122, v116, v59
    v_fmac_f32 v123, v116, v60
    v_lshlrev_b32 v59, 16, v98
    v_and_b32 v60, 0xffff0000, v98
    v_fmac_f32 v124, v116, v59
    v_fmac_f32 v125, v116, v60
    v_lshlrev_b32 v59, 16, v99
    v_and_b32 v60, 0xffff0000, v99
    v_fmac_f32 v126, v116, v59
    v_fmac_f32 v127, v116, v60
    v_lshlrev_b32 v59, 16, v100
    v_and_b32 v60, 0xffff0000, v100
    v_fmac_f32 v120, v117, v59
    v_fmac_f32 v121, v117, v60
    v_lshlrev_b32 v59, 16, v101
    v_and_b32 v60, 0xffff0000, v101
    v_fmac_f32 v122, v117, v59
    v_fmac_f32 v123, v117, v60
    v_lshlrev_b32 v59, 16, v102
    v_and_b32 v60, 0xffff0000, v102
    v_fmac_f32 v124, v117, v59
    v_fmac_f32 v125, v117, v60
    v_lshlrev_b32 v59, 16, v103
    v_and_b32 v60, 0xffff0000, v103
    v_fmac_f32 v126, v117, v59
    v_fmac_f32 v127, v117, v60
    v_lshlrev_b32 v59, 16, v104
    v_and_b32 v60, 0xffff0000, v104
    v_fmac_f32 v120, v118, v59
    v_fmac_f32 v121, v118, v60
    v_lshlrev_b32 v59, 16, v105
    v_and_b32 v60, 0xffff0000, v105
    v_fmac_f32 v122, v118, v59
    v_fmac_f32 v123, v118, v60
    v_lshlrev_b32 v59, 16, v106
    v_and_b32 v60, 0xffff0000, v106
    v_fmac_f32 v124, v118, v59
    v_fmac_f32 v125, v118, v60
    v_lshlrev_b32 v59, 16, v107
    v_and_b32 v60, 0xffff0000, v107
    v_fmac_f32 v126, v118, v59
    v_fmac_f32 v127, v118, v60
    v_lshlrev_b32 v59, 16, v108
    v_and_b32 v60, 0xffff0000, v108
    v_fmac_f32 v120, v119, v59
    v_fmac_f32 v121, v119, v60
    v_lshlrev_b32 v59, 16, v109
    v_and_b32 v60, 0xffff0000, v109
    v_fmac_f32 v122, v119, v59
    v_fmac_f32 v123, v119, v60
    v_lshlrev_b32 v59, 16, v110
    v_and_b32 v60, 0xffff0000, v110
    v_fmac_f32 v124, v119, v59
    v_fmac_f32 v125, v119, v60
    v_lshlrev_b32 v59, 16, v111
    v_and_b32 v60, 0xffff0000, v111
    v_fmac_f32 v126, v119, v59
    v_fmac_f32 v127, v119, v60
    v_mov_b32 v59, v120
    s_nop 1
    v_permlane16_swap_b32 v120, v59
    s_nop 1
    v_add_f32 v120, v120, v59
    v_mov_b32 v59, v120
    s_nop 1
    v_permlane32_swap_b32 v120, v59
    s_nop 1
    v_add_f32 v120, v120, v59
    v_mov_b32 v59, v121
    s_nop 1
    v_permlane16_swap_b32 v121, v59
    s_nop 1
    v_add_f32 v121, v121, v59
    v_mov_b32 v59, v121
    s_nop 1
    v_permlane32_swap_b32 v121, v59
    s_nop 1
    v_add_f32 v121, v121, v59
    v_mov_b32 v59, v122
    s_nop 1
    v_permlane16_swap_b32 v122, v59
    s_nop 1
    v_add_f32 v122, v122, v59
    v_mov_b32 v59, v122
    s_nop 1
    v_permlane32_swap_b32 v122, v59
    s_nop 1
    v_add_f32 v122, v122, v59
    v_mov_b32 v59, v123
    s_nop 1
    v_permlane16_swap_b32 v123, v59
    s_nop 1
    v_add_f32 v123, v123, v59
    v_mov_b32 v59, v123
    s_nop 1
    v_permlane32_swap_b32 v123, v59
    s_nop 1
    v_add_f32 v123, v123, v59
    v_mov_b32 v59, v124
    s_nop 1
    v_permlane16_swap_b32 v124, v59
    s_nop 1
    v_add_f32 v124, v124, v59
    v_mov_b32 v59, v124
    s_nop 1
    v_permlane32_swap_b32 v124, v59
    s_nop 1
    v_add_f32 v124, v124, v59
    v_mov_b32 v59, v125
    s_nop 1
    v_permlane16_swap_b32 v125, v59
    s_nop 1
    v_add_f32 v125, v125, v59
    v_mov_b32 v59, v125
    s_nop 1
    v_permlane32_swap_b32 v125, v59
    s_nop 1
    v_add_f32 v125, v125, v59
    v_mov_b32 v59, v126
    s_nop 1
    v_permlane16_swap_b32 v126, v59
    s_nop 1
    v_add_f32 v126, v126, v59
    v_mov_b32 v59, v126
    s_nop 1
    v_permlane32_swap_b32 v126, v59
    s_nop 1
    v_add_f32 v126, v126, v59
    v_mov_b32 v59, v127
    s_nop 1
    v_permlane16_swap_b32 v127, v59
    s_nop 1
    v_add_f32 v127, v127, v59
    v_mov_b32 v59, v127
    s_nop 1
    v_permlane32_swap_b32 v127, v59
    s_nop 1
    v_add_f32 v127, v127, v59
    v_cvt_pk_bf16_f32 v120, v120, v121
    v_cvt_pk_bf16_f32 v121, v122, v123
    v_cvt_pk_bf16_f32 v122, v124, v125
    v_cvt_pk_bf16_f32 v123, v126, v127
    s_lshl_b32 s6, s5, 8
    s_add_u32 s6, s6, 152576
    v_lshlrev_b32 v59, 4, v4
    v_add_u32 v59, s6, v59
    ds_write_b128 v59, v[120:123]
    s_waitcnt lgkmcnt(0)
    s_barrier
    ds_read_b128 v[64:67], v30 offset:0
    ds_read_b128 v[68:71], v30 offset:64
    ds_read_b128 v[72:75], v30 offset:128
    ds_read_b128 v[76:79], v30 offset:192
    s_waitcnt lgkmcnt(3)
    v_mfma_f32_16x16x32_bf16 v[80:83], v[128:131], v[64:67], 0
    v_mfma_f32_16x16x32_bf16 v[84:87], v[132:135], v[64:67], 0
    s_waitcnt lgkmcnt(2)
    v_mfma_f32_16x16x32_bf16 v[80:83], v[136:139], v[68:71], v[80:83]
    v_mfma_f32_16x16x32_bf16 v[84:87], v[140:143], v[68:71], v[84:87]
    s_waitcnt lgkmcnt(1)
    v_mfma_f32_16x16x32_bf16 v[80:83], v[144:147], v[72:75], v[80:83]
    v_mfma_f32_16x16x32_bf16 v[84:87], v[148:151], v[72:75], v[84:87]
    s_waitcnt lgkmcnt(0)
    v_mfma_f32_16x16x32_bf16 v[80:83], v[152:155], v[76:79], v[80:83]
    v_mfma_f32_16x16x32_bf16 v[84:87], v[156:159], v[76:79], v[84:87]
    v_lshlrev_b32 v59, 8, v4
    v_lshl_add_u32 v59, v3, 4, v59
    s_lshl_b32 s6, s5, 6
    s_add_u32 s6, s6, 153600
    v_add_u32 v59, s6, v59
    v_cmp_gt_u32 vcc, 4, v4
    s_nop 2
    v_cvt_pk_bf16_f32 v80, v80, v81
    v_cvt_pk_bf16_f32 v81, v82, v83
    v_cvt_pk_bf16_f32 v82, v84, v85
    v_cvt_pk_bf16_f32 v83, v86, v87
    s_and_saveexec_b64 s[62:63], vcc
    ds_write_b128 v59, v[80:83]
    s_mov_b64 exec, s[62:63]
    s_waitcnt lgkmcnt(0)
    s_barrier
    v_add_u32 v30, 1024, v30
    ds_read_b128 v[64:67], v30 offset:0
    ds_read_b128 v[68:71], v30 offset:64
    ds_read_b128 v[72:75], v30 offset:128
    ds_read_b128 v[76:79], v30 offset:192
    s_waitcnt lgkmcnt(3)
    v_mfma_f32_16x16x32_bf16 v[80:83], v[160:163], v[64:67], 0
    v_mfma_f32_16x16x32_bf16 v[84:87], v[164:167], v[64:67], 0
    v_mfma_f32_16x16x32_bf16 v[88:91], v[168:171], v[64:67], 0
    v_mfma_f32_16x16x32_bf16 v[92:95], v[172:175], v[64:67], 0
    s_waitcnt lgkmcnt(2)
    v_mfma_f32_16x16x32_bf16 v[80:83], v[176:179], v[68:71], v[80:83]
    v_mfma_f32_16x16x32_bf16 v[84:87], v[180:183], v[68:71], v[84:87]
    v_mfma_f32_16x16x32_bf16 v[88:91], v[184:187], v[68:71], v[88:91]
    v_mfma_f32_16x16x32_bf16 v[92:95], v[188:191], v[68:71], v[92:95]
    s_waitcnt lgkmcnt(1)
    v_mfma_f32_16x16x32_bf16 v[80:83], v[192:195], v[72:75], v[80:83]
    v_mfma_f32_16x16x32_bf16 v[84:87], v[196:199], v[72:75], v[84:87]
    v_mfma_f32_16x16x32_bf16 v[88:91], v[200:203], v[72:75], v[88:91]
    v_mfma_f32_16x16x32_bf16 v[92:95], v[204:207], v[72:75], v[92:95]
    s_waitcnt lgkmcnt(0)
    v_mfma_f32_16x16x32_bf16 v[80:83], v[208:211], v[76:79], v[80:83]
    v_mfma_f32_16x16x32_bf16 v[84:87], v[212:215], v[76:79], v[84:87]
    v_mfma_f32_16x16x32_bf16 v[88:91], v[216:219], v[76:79], v[88:91]
    v_mfma_f32_16x16x32_bf16 v[92:95], v[220:223], v[76:79], v[92:95]
    s_lshr_b32 s6, s4, 2
    s_lshl_b32 s6, s6, 3
    s_lshl_b32 s7, s5, 1
    s_add_u32 s6, s6, s7
    s_mul_i32 s6, s6, 19968
    s_lshl_b32 s7, s3, 2
    s_and_b32 s61, s4, 3
    s_add_u32 s7, s7, s61
    s_lshl_b32 s7, s7, 7
    s_add_u32 s6, s6, s7
    s_add_u32 s6, s6, 1048576
    s_add_u32 s7, s6, 19968
    s_mov_b32 s61, 0xfffffffe
    v_cmp_gt_u32 vcc, 4, v4
    s_and_saveexec_b64 s[62:63], vcc
    s_nop 2
    v_min_u32 v80, s61, v80
    v_min_u32 v81, s61, v81
    v_min_u32 v82, s61, v82
    v_min_u32 v83, s61, v83
    v_min_u32 v84, s61, v84
    v_min_u32 v85, s61, v85
    v_min_u32 v86, s61, v86
    v_min_u32 v87, s61, v87
    v_min_u32 v88, s61, v88
    v_min_u32 v89, s61, v89
    v_min_u32 v90, s61, v90
    v_min_u32 v91, s61, v91
    v_min_u32 v92, s61, v92
    v_min_u32 v93, s61, v93
    v_min_u32 v94, s61, v94
    v_min_u32 v95, s61, v95
    buffer_store_dwordx4 v[80:83], v63, s[36:39], s6 offen sc1
    buffer_store_dwordx4 v[84:87], v63, s[36:39], s6 offen offset:64 sc1
    buffer_store_dwordx4 v[88:91], v63, s[36:39], s7 offen sc1
    buffer_store_dwordx4 v[92:95], v63, s[36:39], s7 offen offset:64 sc1
    s_mov_b64 exec, s[62:63]
    s_cmp_ge_u32 s2, 64
    s_cbranch_scc1 B_FIN
    v_lshrrev_b32 v2, 3, v0
    v_and_b32 v7, 7, v0
    s_mul_i32 s6, s2, 19968
    s_add_u32 s6, s6, 1048576
    v_lshlrev_b32 v58, 4, v0
    s_lshl_b32 s7, s2, 6
    v_lshlrev_b32 v59, 1, v0
    buffer_load_ushort v28, v59, s[8:11], s7 offen
    v_mov_b32 v24, 0
    v_mov_b32 v25, 0
    v_mov_b32 v26, 0
    v_mov_b32 v27, 0
    s_add_u32 s52, s6, 4096
    s_add_u32 s53, s6, 8192
    s_add_u32 s54, s6, 12288
    s_add_u32 s55, s6, 16384
    v_cmp_gt_u32 s[56:57], 28, v2
    s_mov_b32 s58, 40000
E3_POLL:
    buffer_load_dwordx4 v[8:11], v58, s[36:39], s6 offen sc1
    buffer_load_dwordx4 v[12:15], v58, s[36:39], s52 offen sc1
    buffer_load_dwordx4 v[16:19], v58, s[36:39], s53 offen sc1
    buffer_load_dwordx4 v[20:23], v58, s[36:39], s54 offen sc1
    s_mov_b64 exec, s[56:57]
    buffer_load_dwordx4 v[24:27], v58, s[36:39], s55 offen sc1
    s_mov_b64 exec, -1
    s_waitcnt vmcnt(0)
    v_max3_u32 v29, v8, v9, v10
    v_max3_u32 v29, v29, v11, v12
    v_max3_u32 v29, v29, v13, v14
    v_max3_u32 v29, v29, v15, v16
    v_max3_u32 v29, v29, v17, v18
    v_max3_u32 v29, v29, v19, v20
    v_max3_u32 v29, v29, v21, v22
    v_max3_u32 v29, v29, v23, v24
    v_max3_u32 v29, v29, v25, v26
    v_max_u32 v29, v29, v27
    v_cmp_eq_u32 vcc, -1, v29
    s_cbranch_vccz E3_DONE
    s_sub_u32 s58, s58, 1
    s_cmp_eq_u32 s58, 0
    s_cbranch_scc1 E3_DONE
    s_branch E3_POLL
E3_DONE:
    v_add_f32 v8, v8, v12
    v_add_f32 v16, v16, v20
    v_add_f32 v8, v8, v16
    v_add_f32 v9, v9, v13
    v_add_f32 v17, v17, v21
    v_add_f32 v9, v9, v17
    v_add_f32 v10, v10, v14
    v_add_f32 v18, v18, v22
    v_add_f32 v10, v10, v18
    v_add_f32 v11, v11, v15
    v_add_f32 v19, v19, v23
    v_add_f32 v11, v11, v19
    s_nop 1
    v_add_f32_dpp v8, v8, v8 row_ror:8 row_mask:0xf bank_mask:0xf
    v_mov_b32 v29, v8
    s_nop 1
    v_permlane16_swap_b32 v8, v29
    s_nop 1
    v_add_f32 v8, v8, v29
    v_mov_b32 v29, v8
    s_nop 1
    v_permlane32_swap_b32 v8, v29
    s_nop 1
    v_add_f32 v8, v8, v29
    s_nop 1
    v_add_f32_dpp v9, v9, v9 row_ror:8 row_mask:0xf bank_mask:0xf
    v_mov_b32 v29, v9
    s_nop 1
    v_permlane16_swap_b32 v9, v29
    s_nop 1
    v_add_f32 v9, v9, v29
    v_mov_b32 v29, v9
    s_nop 1
    v_permlane32_swap_b32 v9, v29
    s_nop 1
    v_add_f32 v9, v9, v29
    s_nop 1
    v_add_f32_dpp v10, v10, v10 row_ror:8 row_mask:0xf bank_mask:0xf
    v_mov_b32 v29, v10
    s_nop 1
    v_permlane16_swap_b32 v10, v29
    s_nop 1
    v_add_f32 v10, v10, v29
    v_mov_b32 v29, v10
    s_nop 1
    v_permlane32_swap_b32 v10, v29
    s_nop 1
    v_add_f32 v10, v10, v29
    s_nop 1
    v_add_f32_dpp v11, v11, v11 row_ror:8 row_mask:0xf bank_mask:0xf
    v_mov_b32 v29, v11
    s_nop 1
    v_permlane16_swap_b32 v11, v29
    s_nop 1
    v_add_f32 v11, v11, v29
    v_mov_b32 v29, v11
    s_nop 1
    v_permlane32_swap_b32 v11, v29
    s_nop 1
    v_add_f32 v11, v11, v29
    s_nop 1
    v_add_f32_dpp v24, v24, v24 row_ror:8 row_mask:0xf bank_mask:0xf
    v_mov_b32 v29, v24
    s_nop 1
    v_permlane16_swap_b32 v24, v29
    s_nop 1
    v_add_f32 v24, v24, v29
    v_mov_b32 v29, v24
    s_nop 1
    v_permlane32_swap_b32 v24, v29
    s_nop 1
    v_add_f32 v24, v24, v29
    s_nop 1
    v_add_f32_dpp v25, v25, v25 row_ror:8 row_mask:0xf bank_mask:0xf
    v_mov_b32 v29, v25
    s_nop 1
    v_permlane16_swap_b32 v25, v29
    s_nop 1
    v_add_f32 v25, v25, v29
    v_mov_b32 v29, v25
    s_nop 1
    v_permlane32_swap_b32 v25, v29
    s_nop 1
    v_add_f32 v25, v25, v29
    s_nop 1
    v_add_f32_dpp v26, v26, v26 row_ror:8 row_mask:0xf bank_mask:0xf
    v_mov_b32 v29, v26
    s_nop 1
    v_permlane16_swap_b32 v26, v29
    s_nop 1
    v_add_f32 v26, v26, v29
    v_mov_b32 v29, v26
    s_nop 1
    v_permlane32_swap_b32 v26, v29
    s_nop 1
    v_add_f32 v26, v26, v29
    s_nop 1
    v_add_f32_dpp v27, v27, v27 row_ror:8 row_mask:0xf bank_mask:0xf
    v_mov_b32 v29, v27
    s_nop 1
    v_permlane16_swap_b32 v27, v29
    s_nop 1
    v_add_f32 v27, v27, v29
    v_mov_b32 v29, v27
    s_nop 1
    v_permlane32_swap_b32 v27, v29
    s_nop 1
    v_add_f32 v27, v27, v29
    s_lshl_b32 s6, s5, 8
    s_add_u32 s6, s6, 131072
    v_lshlrev_b32 v30, 4, v7
    v_add_u32 v30, s6, v30
    v_cmp_gt_u32 vcc, 8, v1
    s_and_saveexec_b64 s[62:63], vcc
    ds_write_b128 v30, v[8:11]
    ds_write_b128 v30, v[24:27] offset:128
    s_mov_b64 exec, s[62:63]
    s_waitcnt lgkmcnt(0)
    s_barrier
    v_cmp_gt_u32 vcc, 32, v0
    s_and_saveexec_b64 s[62:63], vcc
    s_cbranch_execz B_FIN
    v_lshlrev_b32 v30, 2, v0
    v_add_u32 v30, 131072, v30
    ds_read_b32 v8, v30 offset:0
    ds_read_b32 v12, v30 offset:128
    ds_read_b32 v9, v30 offset:256
    ds_read_b32 v13, v30 offset:384
    ds_read_b32 v10, v30 offset:512
    ds_read_b32 v14, v30 offset:640
    ds_read_b32 v11, v30 offset:768
    ds_read_b32 v15, v30 offset:896
    s_waitcnt lgkmcnt(0)
    v_add_f32 v8, v8, v9
    v_add_f32 v10, v10, v11
    v_add_f32 v8, v8, v10
    v_add_f32 v12, v12, v13
    v_add_f32 v14, v14, v15
    v_add_f32 v12, v12, v14
    v_mul_f32 v13, 0xbfb8aa3b, v12
    v_exp_f32 v13, v13
    s_nop 0
    v_add_f32 v13, 1.0, v13
    v_rcp_f32 v13, v13
    s_nop 0
    v_mul_f32 v12, v12, v13
    v_lshlrev_b32 v28, 16, v28
    v_fmac_f32 v28, v8, v12
    v_cvt_pk_bf16_f32 v28, v28, v28
    buffer_store_short v28, v59, s[44:47], s7 offen
B_FIN:
B_END:
    s_endpgm
.section .rodata,"a"
.p2align 6
.amdhsa_kernel ka_kernel
  .amdhsa_next_free_vgpr 512
  .amdhsa_next_free_sgpr 102
  .amdhsa_accum_offset 256
  .amdhsa_group_segment_fixed_size 0
  .amdhsa_kernarg_size 104
  .amdhsa_user_sgpr_count 2
  .amdhsa_user_sgpr_kernarg_segment_ptr 1
  .amdhsa_system_sgpr_workgroup_id_x 1
.end_amdhsa_kernel
.p2align 6
.amdhsa_kernel kb_kernel
  .amdhsa_next_free_vgpr 512
  .amdhsa_next_free_sgpr 102
  .amdhsa_accum_offset 256
  .amdhsa_group_segment_fixed_size 0
  .amdhsa_kernarg_size 104
  .amdhsa_user_sgpr_count 2
  .amdhsa_user_sgpr_kernarg_segment_ptr 1
  .amdhsa_system_sgpr_workgroup_id_x 1
.end_amdhsa_kernel
```
